```python
import torch

def _softmax(x, axis=-1):
    return torch.softmax(x, dim=axis)
def _gelu(x):
    return torch.nn.functional.gelu(x, approximate="tanh")
def _silu(x):
    return torch.nn.functional.silu(x)
def _sigmoid(x):
    return torch.sigmoid(x)
def _layernorm(x, axis=-1, eps=1e-5):
    m = x.mean(dim=axis, keepdim=True)
    v = x.var(dim=axis, keepdim=True, unbiased=False)
    return (x - m) / torch.sqrt(v + eps)
def _scatter_add(tgt, idx, src, axis=0):
    return tgt.clone().index_add_(axis, idx, src)
def _segment_sum(src, seg, n):
    out = torch.zeros((n,) + src.shape[1:], dtype=src.dtype)
    return out.index_add_(0, seg, src)
def _pad(x, pw):
    flat = tuple(v for pair in reversed(pw) for v in pair)
    return torch.nn.functional.pad(x, flat)

kernel_name = 'sequential_preLN__ssm_conv_s4d__glu_gated_geglu__prompt'

def setup_inputs():

    _w = (lambda a: (lambda t: t.to(torch.bfloat16) if t.is_floating_point() else t)(torch.as_tensor(a)))
    def _A_setup():
        Bsz, L, D, N = 1, 2048, 512, 128
        return {
            "u": _w((lambda *s: torch.randn(*s, dtype=torch.bfloat16) * 0.05)(Bsz, L, D)),
            "log_A_real": _w((lambda *s: torch.randn(*s, dtype=torch.bfloat16) * 6.4)(D, N) * 0.5),
            "A_imag": _w((lambda *s: torch.randn(*s, dtype=torch.bfloat16) * 0.05)(D, N) * 3.14),
            "C_real": _w((lambda *s: torch.randn(*s, dtype=torch.bfloat16) * 0.05)(D, N) / N ** 0.5),
            "C_imag": _w((lambda *s: torch.randn(*s, dtype=torch.bfloat16) * 0.05)(D, N) / N ** 0.5),
            "log_dt": _w((lambda *s: torch.randn(*s, dtype=torch.bfloat16) * 0.05)(D) * 0.5 - 4.0),
            "D_skip": _w((lambda *s: torch.randn(*s, dtype=torch.bfloat16) * 0.05)(D)),
        }
    _A_in = _A_setup()

    def _B_setup():
        B, S, Dm, Df = 1, 2048, 512, 1792
        return {
            "x": _w((lambda *s: torch.randn(*s, dtype=torch.bfloat16) * 0.05)(B, S, Dm)),
            "w_gate": _w((lambda *s: torch.randn(*s, dtype=torch.bfloat16) * 0.4)(Dm, Df) * (Dm ** -0.5)),
            "w_up": _w((lambda *s: torch.randn(*s, dtype=torch.bfloat16) * 0.4)(Dm, Df) * (Dm ** -0.5)),
            "w_down": _w((lambda *s: torch.randn(*s, dtype=torch.bfloat16) * 0.4)(Df, Dm) * (Df ** -0.5)),
        }
    _B_in = _B_setup()

    return {
        "A_u": _A_in["u"],
        "A_log_A_real": _A_in["log_A_real"],
        "A_A_imag": _A_in["A_imag"],
        "A_C_real": _A_in["C_real"],
        "A_C_imag": _A_in["C_imag"],
        "A_log_dt": _A_in["log_dt"],
        "A_D_skip": _A_in["D_skip"],
        "B_x": _B_in["x"],
        "B_w_gate": _B_in["w_gate"],
        "B_w_up": _B_in["w_up"],
        "B_w_down": _B_in["w_down"],
    }

def reference(A_u, A_log_A_real, A_A_imag, A_C_real, A_C_imag, A_log_dt, A_D_skip, B_x, B_w_gate, B_w_up, B_w_down):
    def _A_ref(u, log_A_real, A_imag, C_real, C_imag, log_dt, D_skip):
        L = u.shape[1]
        dt = torch.exp(log_dt)
        A = -torch.exp(log_A_real) + 1j * A_imag
        C = (C_real + 1j * C_imag) * dt[:, None]
        pos = (lambda x, dt: x.to(dt))(torch.arange(L), log_dt.dtype)
        P = torch.exp((A * dt[:, None])[:, :, None] * pos[None, None, :])
        K = 2.0 * torch.einsum("dn,dnl->dl", C, P).real
        L2 = 2 * L
        u_t = (lambda x, *d: x.permute(*d))(u, 0, 2, 1)
        Kf = (lambda x, *a, **k: torch.fft.rfft(x.float(), *a, **k))(K, L2)
        Uf = (lambda x, *a, **k: torch.fft.rfft(x.float(), *a, **k))(u_t, L2)
        y = (lambda x, *a, **k: torch.fft.irfft(x, *a, **k).to(torch.bfloat16))(Uf * Kf[None, :, :], L2)[:, :, :L]
        y = (lambda x, *d: x.permute(*d))(y, 0, 2, 1)
        return y + u * D_skip[None, None, :]

    def _B_ref(x, w_gate, w_up, w_down):
        g = torch.einsum("bsd,df->bsf", x, w_gate)
        u = torch.einsum("bsd,df->bsf", x, w_up)
        h = _gelu(g) * u
        return torch.einsum("bsf,fd->bsd", h, w_down)

    x = A_u
    h = x + _A_ref(_layernorm(x, axis=-1), A_log_A_real, A_A_imag, A_C_real, A_C_imag, A_log_dt, A_D_skip)
    h2 = h + _B_ref(_layernorm(h, axis=-1), B_w_gate, B_w_up, B_w_down)
    return h2
```

```asm
; @launch kernel=k1_kernel grid=(512,1,1) block=(512,1,1) lds=60672
; @launch kernel=k2_kernel grid=(256,1,1) block=(512,1,1) lds=100864
; @launch kernel=k3_kernel grid=(256,1,1) block=(512,1,1) lds=148480
; @launch kernel=k4_kernel grid=(256,1,1) block=(512,1,1) lds=155648
.amdgcn_target "amdgcn-amd-amdhsa--gfx950"
.text
.globl k1_kernel
.p2align 8
.type k1_kernel,@function
k1_kernel:
    s_cmp_ge_u32 s2, 512
    s_cbranch_scc1 L_k1_end
    s_load_dwordx2 s[38:39], s[0:1], 104
    s_getpc_b64 s[70:71]
    v_lshlrev_b32 v90, 4, v0
    global_load_dwordx4 v[92:95], v90, s[70:71]
    v_and_b32 v1, 63, v0
    v_lshrrev_b32 v2, 6, v0
    s_nop 0
    v_readfirstlane_b32 s3, v2
    s_cmp_ge_u32 s2, 256
    s_cbranch_scc1 L_k1_roleB
    s_load_dwordx8 s[64:71], s[0:1], 8
    s_load_dwordx2 s[72:73], s[0:1], 40
    s_lshl_b32 s43, s2, 2
    s_lshl_b32 s44, s2, 9
    v_and_b32 v9, 255, v0
    v_lshl_add_u32 v3, v9, 1, s44
    v_xor_b32 v4, 128, v3
    v_and_b32 v5, 15, v1
    v_lshrrev_b32 v6, 4, v1
    s_mov_b32 s60, 0x3fb8aa3b
    s_mov_b32 s61, 0x32a57060
    s_mov_b32 s62, 0x3f317218
    s_waitcnt lgkmcnt(0)
    s_load_dword s45, s[72:73], s43
    global_load_ushort v10, v3, s[64:65]
    global_load_ushort v11, v3, s[66:67]
    global_load_ushort v12, v3, s[68:69]
    global_load_ushort v13, v3, s[70:71]
    global_load_ushort v14, v4, s[68:69]
    global_load_ushort v15, v4, s[70:71]
    s_mov_b32 s24, s38
    s_mov_b32 s25, s39
    s_mov_b32 s26, 0x1700000
    s_mov_b32 s27, 0x00020000
    v_lshlrev_b32 v51, 3, v9
    v_sub_u32 v51, 2047, v51
    s_mov_b32 s52, 0xffff7b00
    s_lshr_b32 s57, s3, 2
    s_mul_i32 s57, s57, 2176
    s_add_u32 s57, s57, 56320
    v_subrev_u32 v52, 0, v51
    v_cvt_f32_i32 v54, v52
    v_subrev_u32 v53, 1, v51
    v_cvt_f32_i32 v55, v53
    v_cvt_pk_bf16_f32 v56, v54, v55
    v_and_b32 v57, 0xffff, v56
    v_lshl_add_u32 v57, v57, 1, s52
    v_lshlrev_b32 v58, 1, v52
    v_cmp_gt_i32 vcc, 128, v52
    s_nop 1
    v_cndmask_b32 v40, v57, v58, vcc
    v_add_u32 v40, s57, v40
    v_lshrrev_b32 v57, 16, v56
    v_lshl_add_u32 v57, v57, 1, s52
    v_lshlrev_b32 v58, 1, v53
    v_cmp_gt_i32 vcc, 128, v53
    s_nop 1
    v_cndmask_b32 v41, v57, v58, vcc
    v_add_u32 v41, s57, v41
    v_subrev_u32 v52, 2, v51
    v_cvt_f32_i32 v54, v52
    v_subrev_u32 v53, 3, v51
    v_cvt_f32_i32 v55, v53
    v_cvt_pk_bf16_f32 v56, v54, v55
    v_and_b32 v57, 0xffff, v56
    v_lshl_add_u32 v57, v57, 1, s52
    v_lshlrev_b32 v58, 1, v52
    v_cmp_gt_i32 vcc, 128, v52
    s_nop 1
    v_cndmask_b32 v42, v57, v58, vcc
    v_add_u32 v42, s57, v42
    v_lshrrev_b32 v57, 16, v56
    v_lshl_add_u32 v57, v57, 1, s52
    v_lshlrev_b32 v58, 1, v53
    v_cmp_gt_i32 vcc, 128, v53
    s_nop 1
    v_cndmask_b32 v43, v57, v58, vcc
    v_add_u32 v43, s57, v43
    v_subrev_u32 v52, 4, v51
    v_cvt_f32_i32 v54, v52
    v_subrev_u32 v53, 5, v51
    v_cvt_f32_i32 v55, v53
    v_cvt_pk_bf16_f32 v56, v54, v55
    v_and_b32 v57, 0xffff, v56
    v_lshl_add_u32 v57, v57, 1, s52
    v_lshlrev_b32 v58, 1, v52
    v_cmp_gt_i32 vcc, 128, v52
    s_nop 1
    v_cndmask_b32 v44, v57, v58, vcc
    v_add_u32 v44, s57, v44
    v_lshrrev_b32 v57, 16, v56
    v_lshl_add_u32 v57, v57, 1, s52
    v_lshlrev_b32 v58, 1, v53
    v_cmp_gt_i32 vcc, 128, v53
    s_nop 1
    v_cndmask_b32 v45, v57, v58, vcc
    v_add_u32 v45, s57, v45
    v_subrev_u32 v52, 6, v51
    v_cvt_f32_i32 v54, v52
    v_subrev_u32 v53, 7, v51
    v_cvt_f32_i32 v55, v53
    v_cvt_pk_bf16_f32 v56, v54, v55
    v_and_b32 v57, 0xffff, v56
    v_lshl_add_u32 v57, v57, 1, s52
    v_lshlrev_b32 v58, 1, v52
    v_cmp_gt_i32 vcc, 128, v52
    s_nop 1
    v_cndmask_b32 v46, v57, v58, vcc
    v_add_u32 v46, s57, v46
    v_lshrrev_b32 v57, 16, v56
    v_lshl_add_u32 v57, v57, 1, s52
    v_lshlrev_b32 v58, 1, v53
    v_cmp_gt_i32 vcc, 128, v53
    s_nop 1
    v_cndmask_b32 v47, v57, v58, vcc
    v_add_u32 v47, s57, v47
    s_bfe_u32 s53, s3, 0x10001
    s_lshl_b32 s54, s53, 4
    v_and_b32 v58, 127, v0
    v_lshlrev_b32 v58, 2, v58
    s_waitcnt lgkmcnt(0)
    s_lshr_b32 s55, s45, s54
    s_lshl_b32 s55, s55, 16
    v_mov_b32 v52, s55
    v_mul_f32 v54, s60, v52
    v_fma_f32 v55, v52, s60, -v54
    v_fma_f32 v55, v52, s61, v55
    v_exp_f32 v53, v54
    v_mul_f32 v55, s62, v55
    v_fma_f32 v53, v53, v55, v53
    v_cvt_pk_bf16_f32 v53, v53, v53
    v_lshlrev_b32 v53, 16, v53
    s_waitcnt vmcnt(0)
    v_lshlrev_b32 v10, 16, v10
    v_lshlrev_b32 v11, 16, v11
    v_lshlrev_b32 v12, 16, v12
    v_lshlrev_b32 v13, 16, v13
    v_lshlrev_b32 v14, 16, v14
    v_lshlrev_b32 v15, 16, v15
    v_mul_f32 v55, s60, v10
    v_fma_f32 v56, v10, s60, -v55
    v_fma_f32 v56, v10, s61, v56
    v_exp_f32 v54, v55
    v_mul_f32 v56, s62, v56
    v_fma_f32 v54, v54, v56, v54
    v_cvt_pk_bf16_f32 v54, v54, v54
    v_lshlrev_b32 v54, 16, v54
    v_mul_f32 v54, v54, v53
    v_mul_f32 v55, v11, v53
    v_mul_f32 v54, 0xbfb8aa3b, v54
    v_mul_f32 v55, 0.15915494, v55
    s_cmp_ge_u32 s3, 4
    s_cbranch_scc1 L_k1_hi
    v_max3_f32 v56, abs(v12), abs(v13), abs(v14)
    v_max_f32 v56, v56, abs(v15)
    v_mul_f32 v62, 0x41000000, v54
    v_mul_f32 v63, 0x41000000, v55
    v_exp_f32 v62, v62
    v_fract_f32 v63, v63
    v_cos_f32 v66, v63
    v_sin_f32 v67, v63
    v_mul_f32 v66, v66, v62
    v_mul_f32 v67, v67, v62
    v_max_f32_dpp v56, v56, v56 row_ror:8 row_mask:0xf bank_mask:0xf
    s_nop 1
    v_max_f32_dpp v56, v56, v56 row_ror:4 row_mask:0xf bank_mask:0xf
    s_nop 1
    v_max_f32_dpp v56, v56, v56 row_ror:2 row_mask:0xf bank_mask:0xf
    s_nop 1
    v_max_f32_dpp v56, v56, v56 row_ror:1 row_mask:0xf bank_mask:0xf
    v_mov_b32 v57, v56
    s_nop 1
    v_permlane16_swap_b32 v56, v57
    v_max_f32 v56, v56, v57
    v_mov_b32 v57, v56
    s_nop 1
    v_permlane32_swap_b32 v56, v57
    v_max_f32 v56, v56, v57
    v_pk_mul_f32 v[74:75], v[66:67], v[66:67] op_sel:[0,0] op_sel_hi:[0,1]
    v_pk_fma_f32 v[74:75], v[66:67], v[66:67], v[74:75] op_sel:[1,1,0] op_sel_hi:[1,0,1] neg_lo:[0,1,0]
    v_frexp_exp_i32_f32 v57, v56
    v_sub_u32 v59, 0, v57
    v_ldexp_f32 v60, v12, v59
    v_ldexp_f32 v61, v13, v59
    v_add_f32 v59, v53, v53
    v_ldexp_f32 v59, v59, v57
    s_mul_i32 s55, s53, 16896
    s_add_u32 s55, s55, 22528
    v_add_u32 v63, s55, v58
    v_pk_mul_f32 v[78:79], v[60:61], v[66:67] op_sel:[0,0] op_sel_hi:[0,1]
    v_pk_fma_f32 v[78:79], v[60:61], v[66:67], v[78:79] op_sel:[1,1,0] op_sel_hi:[1,0,1] neg_lo:[0,1,0]
    s_lshl_b32 s55, s53, 2
    s_lshl_b32 s56, s2, 3
    s_add_u32 s55, s55, s56
    s_add_u32 s55, s55, 0x8000
    v_mov_b32 v62, 0
    buffer_store_dword v59, v62, s[24:27], s55 offen sc1
    s_mov_b32 s55, 0
L_k1_lo:
    v_cvt_pk_f16_f32 v84, v60, -v61
    v_cvt_pk_f16_f32 v85, v78, -v79
    v_pk_mul_f32 v[80:81], v[60:61], v[74:75] op_sel:[0,0] op_sel_hi:[0,1]
    v_pk_fma_f32 v[80:81], v[60:61], v[74:75], v[80:81] op_sel:[1,1,0] op_sel_hi:[1,0,1] neg_lo:[0,1,0]
    v_pk_mul_f32 v[82:83], v[78:79], v[74:75] op_sel:[0,0] op_sel_hi:[0,1]
    v_pk_fma_f32 v[82:83], v[78:79], v[74:75], v[82:83] op_sel:[1,1,0] op_sel_hi:[1,0,1] neg_lo:[0,1,0]
    ds_write_b32 v63, v84
    ds_write_b32 v63, v85 offset:528
    v_cvt_pk_f16_f32 v86, v80, -v81
    v_cvt_pk_f16_f32 v87, v82, -v83
    v_pk_mul_f32 v[60:61], v[80:81], v[74:75] op_sel:[0,0] op_sel_hi:[0,1]
    v_pk_fma_f32 v[60:61], v[80:81], v[74:75], v[60:61] op_sel:[1,1,0] op_sel_hi:[1,0,1] neg_lo:[0,1,0]
    v_pk_mul_f32 v[78:79], v[82:83], v[74:75] op_sel:[0,0] op_sel_hi:[0,1]
    v_pk_fma_f32 v[78:79], v[82:83], v[74:75], v[78:79] op_sel:[1,1,0] op_sel_hi:[1,0,1] neg_lo:[0,1,0]
    ds_write_b32 v63, v86 offset:1056
    ds_write_b32 v63, v87 offset:1584
    v_add_u32 v63, 2112, v63
    s_add_u32 s55, s55, 1
    s_cmp_lt_u32 s55, 8
    s_cbranch_scc1 L_k1_lo
    s_branch L_k1_kb
L_k1_hi:
    s_mul_i32 s55, s53, 11264
    v_add_u32 v62, s55, v58
    v_exp_f32 v56, v54
    v_fract_f32 v57, v55
    v_cos_f32 v64, v57
    v_sin_f32 v65, v57
    v_mul_f32 v64, v64, v56
    v_mul_f32 v65, v65, v56
    v_mul_f32 v56, 0x43800000, v54
    v_mul_f32 v57, 0x43800000, v55
    v_exp_f32 v56, v56
    v_fract_f32 v57, v57
    v_cos_f32 v68, v57
    v_sin_f32 v69, v57
    v_mul_f32 v68, v68, v56
    v_mul_f32 v69, v69, v56
    v_mul_f32 v56, 0x44000000, v54
    v_mul_f32 v57, 0x44000000, v55
    v_exp_f32 v56, v56
    v_fract_f32 v57, v57
    v_cos_f32 v70, v57
    v_sin_f32 v71, v57
    v_mul_f32 v70, v70, v56
    v_mul_f32 v71, v71, v56
    v_mul_f32 v56, 0x44800000, v54
    v_mul_f32 v57, 0x44800000, v55
    v_exp_f32 v56, v56
    v_fract_f32 v57, v57
    v_cos_f32 v72, v57
    v_sin_f32 v73, v57
    v_mul_f32 v72, v72, v56
    v_mul_f32 v73, v73, v56
    v_mov_b32 v84, 0x3c00
    ds_write_b32 v62, v84
    v_pk_mul_f32 v[90:91], v[64:65], v[64:65] op_sel:[0,0] op_sel_hi:[0,1]
    v_pk_fma_f32 v[90:91], v[64:65], v[64:65], v[90:91] op_sel:[1,1,0] op_sel_hi:[1,0,1] neg_lo:[0,1,0]
    v_pk_mul_f32 v[110:111], v[70:71], v[68:69] op_sel:[0,0] op_sel_hi:[0,1]
    v_pk_fma_f32 v[110:111], v[70:71], v[68:69], v[110:111] op_sel:[1,1,0] op_sel_hi:[1,0,1] neg_lo:[0,1,0]
    v_pk_mul_f32 v[114:115], v[72:73], v[68:69] op_sel:[0,0] op_sel_hi:[0,1]
    v_pk_fma_f32 v[114:115], v[72:73], v[68:69], v[114:115] op_sel:[1,1,0] op_sel_hi:[1,0,1] neg_lo:[0,1,0]
    v_pk_mul_f32 v[116:117], v[72:73], v[70:71] op_sel:[0,0] op_sel_hi:[0,1]
    v_pk_fma_f32 v[116:117], v[72:73], v[70:71], v[116:117] op_sel:[1,1,0] op_sel_hi:[1,0,1] neg_lo:[0,1,0]
    v_pk_mul_f32 v[120:121], v[72:73], v[72:73] op_sel:[0,0] op_sel_hi:[0,1]
    v_pk_fma_f32 v[120:121], v[72:73], v[72:73], v[120:121] op_sel:[1,1,0] op_sel_hi:[1,0,1] neg_lo:[0,1,0]
    v_cvt_pk_f16_f32 v85, v64, v65
    ds_write_b32 v62, v85 offset:528
    v_cvt_pk_f16_f32 v86, v68, v69
    ds_write_b32 v62, v86 offset:4224
    v_cvt_pk_f16_f32 v87, v70, v71
    ds_write_b32 v62, v87 offset:6336
    v_cvt_pk_f16_f32 v84, v72, v73
    ds_write_b32 v62, v84 offset:8448
    v_pk_mul_f32 v[92:93], v[90:91], v[64:65] op_sel:[0,0] op_sel_hi:[0,1]
    v_pk_fma_f32 v[92:93], v[90:91], v[64:65], v[92:93] op_sel:[1,1,0] op_sel_hi:[1,0,1] neg_lo:[0,1,0]
    v_pk_mul_f32 v[94:95], v[90:91], v[90:91] op_sel:[0,0] op_sel_hi:[0,1]
    v_pk_fma_f32 v[94:95], v[90:91], v[90:91], v[94:95] op_sel:[1,1,0] op_sel_hi:[1,0,1] neg_lo:[0,1,0]
    v_pk_mul_f32 v[102:103], v[68:69], v[90:91] op_sel:[0,0] op_sel_hi:[0,1]
    v_pk_fma_f32 v[102:103], v[68:69], v[90:91], v[102:103] op_sel:[1,1,0] op_sel_hi:[1,0,1] neg_lo:[0,1,0]
    v_pk_mul_f32 v[118:119], v[72:73], v[110:111] op_sel:[0,0] op_sel_hi:[0,1]
    v_pk_fma_f32 v[118:119], v[72:73], v[110:111], v[118:119] op_sel:[1,1,0] op_sel_hi:[1,0,1] neg_lo:[0,1,0]
    v_cvt_pk_f16_f32 v85, v90, v91
    ds_write_b32 v62, v85 offset:1056
    v_cvt_pk_f16_f32 v86, v110, v111
    ds_write_b32 v62, v86 offset:7392
    v_cvt_pk_f16_f32 v87, v114, v115
    ds_write_b32 v62, v87 offset:8976
    v_cvt_pk_f16_f32 v84, v116, v117
    ds_write_b32 v62, v84 offset:9504
    v_cvt_pk_f16_f32 v85, v120, v121
    ds_write_b32 v62, v85 offset:10560
    v_pk_mul_f32 v[96:97], v[94:95], v[64:65] op_sel:[0,0] op_sel_hi:[0,1]
    v_pk_fma_f32 v[96:97], v[94:95], v[64:65], v[96:97] op_sel:[1,1,0] op_sel_hi:[1,0,1] neg_lo:[0,1,0]
    v_pk_mul_f32 v[98:99], v[94:95], v[90:91] op_sel:[0,0] op_sel_hi:[0,1]
    v_pk_fma_f32 v[98:99], v[94:95], v[90:91], v[98:99] op_sel:[1,1,0] op_sel_hi:[1,0,1] neg_lo:[0,1,0]
    v_pk_mul_f32 v[100:101], v[94:95], v[92:93] op_sel:[0,0] op_sel_hi:[0,1]
    v_pk_fma_f32 v[100:101], v[94:95], v[92:93], v[100:101] op_sel:[1,1,0] op_sel_hi:[1,0,1] neg_lo:[0,1,0]
    v_pk_mul_f32 v[104:105], v[68:69], v[94:95] op_sel:[0,0] op_sel_hi:[0,1]
    v_pk_fma_f32 v[104:105], v[68:69], v[94:95], v[104:105] op_sel:[1,1,0] op_sel_hi:[1,0,1] neg_lo:[0,1,0]
    v_pk_mul_f32 v[108:109], v[70:71], v[94:95] op_sel:[0,0] op_sel_hi:[0,1]
    v_pk_fma_f32 v[108:109], v[70:71], v[94:95], v[108:109] op_sel:[1,1,0] op_sel_hi:[1,0,1] neg_lo:[0,1,0]
    v_pk_mul_f32 v[112:113], v[110:111], v[94:95] op_sel:[0,0] op_sel_hi:[0,1]
    v_pk_fma_f32 v[112:113], v[110:111], v[94:95], v[112:113] op_sel:[1,1,0] op_sel_hi:[1,0,1] neg_lo:[0,1,0]
    v_cvt_pk_f16_f32 v86, v92, v93
    ds_write_b32 v62, v86 offset:1584
    v_cvt_pk_f16_f32 v87, v94, v95
    ds_write_b32 v62, v87 offset:2112
    v_cvt_pk_f16_f32 v84, v102, v103
    ds_write_b32 v62, v84 offset:4752
    v_cvt_pk_f16_f32 v85, v118, v119
    ds_write_b32 v62, v85 offset:10032
    v_pk_mul_f32 v[106:107], v[68:69], v[98:99] op_sel:[0,0] op_sel_hi:[0,1]
    v_pk_fma_f32 v[106:107], v[68:69], v[98:99], v[106:107] op_sel:[1,1,0] op_sel_hi:[1,0,1] neg_lo:[0,1,0]
    v_cvt_pk_f16_f32 v86, v96, v97
    ds_write_b32 v62, v86 offset:2640
    v_cvt_pk_f16_f32 v87, v98, v99
    ds_write_b32 v62, v87 offset:3168
    v_cvt_pk_f16_f32 v84, v100, v101
    ds_write_b32 v62, v84 offset:3696
    v_cvt_pk_f16_f32 v85, v104, v105
    ds_write_b32 v62, v85 offset:5280
    v_cvt_pk_f16_f32 v86, v108, v109
    ds_write_b32 v62, v86 offset:6864
    v_cvt_pk_f16_f32 v87, v112, v113
    ds_write_b32 v62, v87 offset:7920
    v_cvt_pk_f16_f32 v84, v106, v107
    ds_write_b32 v62, v84 offset:5808
L_k1_kb:
    s_movk_i32 s55, 528
    v_lshlrev_b32 v56, 4, v6
    v_mad_u32_u24 v56, v5, s55, v56
    s_lshr_b32 s58, s3, 2
    s_mul_i32 s59, s58, 8448
    s_mul_i32 s55, s53, 11264
    s_add_u32 s55, s55, s59
    v_add_u32 v57, s55, v56
    s_and_b32 s56, s3, 1
    s_mul_i32 s59, s56, 8448
    s_mul_i32 s55, s53, 16896
    s_add_u32 s55, s55, s59
    s_add_u32 s55, s55, 22528
    v_add_u32 v58, s55, v56
    s_lshl_b32 s55, s56, 4
    v_add_u32 v59, s55, v5
    v_lshlrev_b32 v60, 4, v59
    v_lshl_add_u32 v60, v6, 3, v60
    v_lshlrev_b32 v61, 3, v59
    v_add_u32 v61, 512, v61
    v_lshlrev_b32 v62, 2, v59
    v_add_u32 v62, 768, v62
    v_cmp_eq_u32 vcc, 2, v6
    s_nop 1
    v_cndmask_b32 v60, v60, v61, vcc
    v_cmp_eq_u32 vcc, 3, v6
    s_nop 1
    v_cndmask_b32 v60, v60, v62, vcc
    v_mov_b32 v61, 4
    v_mov_b32 v62, 128
    v_cndmask_b32 v61, v61, v62, vcc
    v_add_u32 v61, v61, v60
    s_mul_i32 s55, s53, 2176
    s_add_u32 s55, s55, 56320
    v_add_u32 v60, s55, v60
    v_add_u32 v61, s55, v61
    v_lshlrev_b32 v62, 1, v59
    v_lshl_add_u32 v62, v6, 8, v62
    v_add_u32 v62, s55, v62
    s_waitcnt lgkmcnt(0)
    s_barrier
    ds_read_b128 v[64:67], v58 offset:0
    ds_read_b128 v[96:99], v57 offset:0
    ds_read_b128 v[68:71], v58 offset:64
    ds_read_b128 v[100:103], v57 offset:64
    ds_read_b128 v[72:75], v58 offset:128
    ds_read_b128 v[104:107], v57 offset:128
    ds_read_b128 v[76:79], v58 offset:192
    ds_read_b128 v[108:111], v57 offset:192
    ds_read_b128 v[80:83], v58 offset:256
    ds_read_b128 v[112:115], v57 offset:256
    ds_read_b128 v[84:87], v58 offset:320
    ds_read_b128 v[116:119], v57 offset:320
    ds_read_b128 v[88:91], v58 offset:384
    ds_read_b128 v[120:123], v57 offset:384
    ds_read_b128 v[92:95], v58 offset:448
    ds_read_b128 v[124:127], v57 offset:448
    s_waitcnt lgkmcnt(14)
    v_mfma_f32_16x16x32_f16 v[16:19], v[96:99], v[64:67], 0
    s_waitcnt lgkmcnt(12)
    v_mfma_f32_16x16x32_f16 v[16:19], v[100:103], v[68:71], v[16:19]
    s_waitcnt lgkmcnt(10)
    v_mfma_f32_16x16x32_f16 v[16:19], v[104:107], v[72:75], v[16:19]
    s_waitcnt lgkmcnt(8)
    v_mfma_f32_16x16x32_f16 v[16:19], v[108:111], v[76:79], v[16:19]
    s_waitcnt lgkmcnt(6)
    v_mfma_f32_16x16x32_f16 v[16:19], v[112:115], v[80:83], v[16:19]
    s_waitcnt lgkmcnt(4)
    v_mfma_f32_16x16x32_f16 v[16:19], v[116:119], v[84:87], v[16:19]
    s_waitcnt lgkmcnt(2)
    v_mfma_f32_16x16x32_f16 v[16:19], v[120:123], v[88:91], v[16:19]
    s_waitcnt lgkmcnt(0)
    v_mfma_f32_16x16x32_f16 v[16:19], v[124:127], v[92:95], v[16:19]
    s_nop 7
    v_cvt_pk_f16_f32 v64, v16, v17
    v_cvt_pk_f16_f32 v65, v18, v19
    s_cmp_ge_u32 s3, 4
    s_cbranch_scc1 L_k1_t1
    ds_write_b32 v60, v64
    ds_write_b32 v61, v65
    s_branch L_k1_t2
L_k1_t1:
    ds_write_b16 v62, v64 offset:1024
    ds_write_b16_d16_hi v62, v64 offset:1088
    ds_write_b16 v62, v65 offset:1152
    ds_write_b16_d16_hi v62, v65 offset:1216
L_k1_t2:
    s_lshl_b32 s55, s2, 1
    s_lshr_b32 s56, s3, 2
    s_add_u32 s55, s55, s56
    s_mul_i32 s55, s55, 4160
    s_add_u32 s55, s55, 0x1200000
    v_lshlrev_b32 v56, 4, v9
    s_waitcnt lgkmcnt(0)
    s_barrier
    ds_read_u16 v64, v40
    ds_read_u16 v65, v41
    ds_read_u16 v66, v42
    ds_read_u16 v67, v43
    ds_read_u16 v68, v44
    ds_read_u16 v69, v45
    ds_read_u16 v70, v46
    ds_read_u16 v71, v47
    v_mov_b32 v80, 0
    v_mov_b32 v81, 0
    v_mov_b32 v82, 0
    v_mov_b32 v83, 0
    s_waitcnt lgkmcnt(6)
    v_lshl_or_b32 v72, v65, 16, v64
    s_waitcnt lgkmcnt(4)
    v_lshl_or_b32 v73, v67, 16, v66
    s_waitcnt lgkmcnt(2)
    v_lshl_or_b32 v74, v69, 16, v68
    s_waitcnt lgkmcnt(0)
    v_lshl_or_b32 v75, v71, 16, v70
    buffer_store_dwordx4 v[72:75], v56, s[24:27], s55 offen sc1
    v_cmp_eq_u32 vcc, 255, v9
    s_nop 0
    s_and_saveexec_b64 s[52:53], vcc
    s_cbranch_execz L_k1_a_end
    buffer_store_dwordx4 v[80:83], v56, s[24:27], s55 offen offset:16 sc1
L_k1_a_end:
    s_endpgm
L_k1_roleB:
    s_load_dwordx2 s[4:5], s[0:1], 0
    s_sub_u32 s2, s2, 256
    v_lshlrev_b32 v3, 4, v1
    v_and_b32 v9, 7, v1
    v_lshrrev_b32 v10, 3, v1
    v_lshlrev_b32 v11, 12, v9
    v_lshl_add_u32 v11, v10, 4, v11
    v_lshlrev_b32 v12, 15, v10
    v_lshl_add_u32 v12, v9, 4, v12
    s_lshl_b32 s51, s2, 1
    s_and_b32 s52, s3, 1
    s_add_u32 s51, s51, s52
    s_lshr_b32 s52, s51, 3
    s_and_b32 s53, s51, 7
    s_lshl_b32 s54, s52, 15
    s_lshl_b32 s55, s53, 7
    s_add_u32 s54, s54, s55
    s_lshl_b32 s66, s53, 18
    s_lshl_b32 s55, s52, 7
    s_add_u32 s66, s66, s55
    s_add_u32 s66, s66, 0x1000000
    s_lshl_b32 s46, s2, 3
    s_add_u32 s46, s46, s3
    s_lshl_b32 s47, s46, 10
    s_waitcnt lgkmcnt(0)
    s_mov_b32 s8, s4
    s_mov_b32 s9, s5
    s_mov_b32 s10, 0x200000
    s_mov_b32 s11, 0x00020000
    s_mov_b32 s24, s38
    s_mov_b32 s25, s39
    s_mov_b32 s26, 0x1700000
    s_mov_b32 s27, 0x00020000
    buffer_load_dwordx4 v[16:19], v3, s[8:11], s47 offen
    s_cmp_ge_u32 s3, 2
    s_cbranch_scc1 L_k1_b1
    buffer_load_dwordx4 v[104:107], v11, s[8:11], s54 offen offset:0
    buffer_load_dwordx4 v[108:111], v11, s[8:11], s54 offen offset:1024
    buffer_load_dwordx4 v[112:115], v11, s[8:11], s54 offen offset:2048
    buffer_load_dwordx4 v[116:119], v11, s[8:11], s54 offen offset:3072
    s_waitcnt vmcnt(0)
    v_swap_b32 v105, v108
    v_swap_b32 v106, v112
    v_swap_b32 v107, v116
    v_swap_b32 v110, v113
    v_swap_b32 v111, v117
    v_swap_b32 v115, v118
    buffer_store_dwordx4 v[104:107], v12, s[24:27], s66 offen sc1
    s_add_u32 s66, s66, 8192
    buffer_store_dwordx4 v[108:111], v12, s[24:27], s66 offen sc1
    s_add_u32 s66, s66, 8192
    buffer_store_dwordx4 v[112:115], v12, s[24:27], s66 offen sc1
    s_add_u32 s66, s66, 8192
    buffer_store_dwordx4 v[116:119], v12, s[24:27], s66 offen sc1
    s_branch L_k1_b2
L_k1_b1:
    s_waitcnt vmcnt(0)
L_k1_b2:
    v_lshlrev_b32 v32, 16, v16
    v_and_b32 v33, 0xffff0000, v16
    v_lshlrev_b32 v34, 16, v17
    v_and_b32 v35, 0xffff0000, v17
    v_lshlrev_b32 v36, 16, v18
    v_and_b32 v37, 0xffff0000, v18
    v_lshlrev_b32 v38, 16, v19
    v_and_b32 v39, 0xffff0000, v19
    v_add_f32 v48, v32, v33
    v_add_f32 v49, v34, v35
    v_add_f32 v50, v36, v37
    v_add_f32 v51, v38, v39
    v_add_f32 v48, v48, v49
    v_add_f32 v50, v50, v51
    v_add_f32 v48, v48, v50
    s_nop 1
    v_add_f32_dpp v48, v48, v48 row_ror:8 row_mask:0xf bank_mask:0xf
    s_nop 1
    v_add_f32_dpp v48, v48, v48 row_ror:4 row_mask:0xf bank_mask:0xf
    s_nop 1
    v_add_f32_dpp v48, v48, v48 row_ror:2 row_mask:0xf bank_mask:0xf
    s_nop 1
    v_add_f32_dpp v48, v48, v48 row_ror:1 row_mask:0xf bank_mask:0xf
    v_mov_b32 v50, v48
    s_nop 1
    v_permlane16_swap_b32 v48, v50
    v_add_f32 v48, v48, v50
    v_mov_b32 v50, v48
    s_nop 1
    v_permlane32_swap_b32 v48, v50
    v_add_f32 v48, v48, v50
    v_mul_f32 v48, 0x3b000000, v48
    v_sub_f32 v32, v32, v48
    v_sub_f32 v33, v33, v48
    v_sub_f32 v34, v34, v48
    v_sub_f32 v35, v35, v48
    v_sub_f32 v36, v36, v48
    v_sub_f32 v37, v37, v48
    v_sub_f32 v38, v38, v48
    v_sub_f32 v39, v39, v48
    v_mul_f32 v52, v32, v32
    v_mul_f32 v53, v33, v33
    v_fmac_f32 v52, v34, v34
    v_fmac_f32 v53, v35, v35
    v_fmac_f32 v52, v36, v36
    v_fmac_f32 v53, v37, v37
    v_fmac_f32 v52, v38, v38
    v_fmac_f32 v53, v39, v39
    v_add_f32 v52, v52, v53
    s_nop 1
    v_add_f32_dpp v52, v52, v52 row_ror:8 row_mask:0xf bank_mask:0xf
    s_nop 1
    v_add_f32_dpp v52, v52, v52 row_ror:4 row_mask:0xf bank_mask:0xf
    s_nop 1
    v_add_f32_dpp v52, v52, v52 row_ror:2 row_mask:0xf bank_mask:0xf
    s_nop 1
    v_add_f32_dpp v52, v52, v52 row_ror:1 row_mask:0xf bank_mask:0xf
    v_mov_b32 v50, v52
    s_nop 1
    v_permlane16_swap_b32 v52, v50
    v_add_f32 v52, v52, v50
    v_mov_b32 v50, v52
    s_nop 1
    v_permlane32_swap_b32 v52, v50
    v_add_f32 v52, v52, v50
    v_mul_f32 v52, 0x3b000000, v52
    v_cvt_pk_bf16_f32 v56, v48, v48
    v_lshlrev_b32 v56, 16, v56
    v_cvt_pk_bf16_f32 v52, v52, v52
    v_lshlrev_b32 v52, 16, v52
    v_add_f32 v52, 0x3727c5ac, v52
    v_cvt_pk_bf16_f32 v52, v52, v52
    v_lshlrev_b32 v52, 16, v52
    v_sqrt_f32 v52, v52
    s_nop 0
    v_cvt_pk_bf16_f32 v52, v52, v52
    v_lshlrev_b32 v52, 16, v52
    v_rcp_f32 v57, v52
    s_lshl_b32 s47, s46, 2
    s_add_u32 s67, s47, 8192
    v_mov_b32 v60, 0
    v_cmp_eq_u32 vcc, 0, v1
    s_nop 0
    s_and_saveexec_b64 s[68:69], vcc
    buffer_store_dword v56, v60, s[24:27], s47 offen sc1
    buffer_store_dword v57, v60, s[24:27], s67 offen sc1
L_k1_end:
    s_endpgm
.globl k2_kernel
.p2align 8
.type k2_kernel,@function
k2_kernel:
    s_cmp_ge_u32 s2, 256
    s_cbranch_scc1 L_k2_end
    s_load_dwordx2 s[38:39], s[0:1], 104
    s_load_dwordx2 s[36:37], s[0:1], 48
    s_load_dwordx4 s[32:35], s[0:1], 64
    s_load_dwordx2 s[6:7], s[0:1], 80
    v_and_b32 v1, 63, v0
    v_lshrrev_b32 v2, 6, v0
    s_nop 0
    v_readfirstlane_b32 s3, v2
    s_and_b32 s40, s2, 7
    s_lshr_b32 s42, s2, 3
    s_lshl_b32 s43, s2, 2
    v_and_b32 v5, 15, v1
    v_lshrrev_b32 v6, 4, v1
    v_lshlrev_b32 v7, 2, v1
    v_lshlrev_b32 v8, 2, v7
    v_lshlrev_b32 v9, 3, v7
    v_lshlrev_b32 v3, 4, v1
    s_lshl_b32 s44, s2, 1
    s_lshr_b32 s45, s3, 2
    s_add_u32 s44, s44, s45
    s_mul_i32 s44, s44, 4160
    s_add_u32 s44, s44, 0x1200000
    v_and_b32 v10, 255, v0
    v_lshlrev_b32 v10, 4, v10
    s_mul_i32 s45, s45, 16640
    v_add_u32 v11, s45, v10
    s_lshl_b32 s47, s2, 13
    s_lshl_b32 s48, s3, 10
    s_add_u32 s47, s47, s48
    s_add_u32 s47, s47, 0x1000000
    s_lshl_b32 s49, s3, 10
    s_add_u32 s59, s49, 8192
    s_lshl_b32 s50, s2, 3
    s_add_u32 s50, s50, 0x8000
    s_waitcnt lgkmcnt(0)
    s_mov_b32 s24, s38
    s_mov_b32 s25, s39
    s_mov_b32 s26, 0x1700000
    s_mov_b32 s27, 0x00020000
    s_load_dword s46, s[36:37], s43
    s_load_dwordx2 s[52:53], s[38:39], s50
    buffer_load_dwordx4 v[16:19], v8, s[24:27], s47 offen
    buffer_load_dwordx4 v[24:27], v3, s[24:27], s49 offen
    buffer_load_dwordx4 v[28:31], v3, s[24:27], s59 offen
    buffer_load_dwordx4 v[64:67], v10, s[24:27], s44 offen
    buffer_load_dwordx2 v[68:69], v10, s[24:27], s44 offen offset:16
    s_mul_i32 s60, s42, 37
    s_lshr_b32 s60, s60, 8
    s_mul_i32 s61, s60, 7
    s_sub_u32 s61, s42, s61
    s_mul_i32 s62, s40, 7
    s_add_u32 s61, s61, s62
    s_and_b32 s63, s42, 15
    s_lshr_b32 s64, s2, 7
    s_lshl_b32 s64, s64, 3
    s_or_b32 s64, s64, s40
    s_and_b32 s65, s3, 3
    v_lshrrev_b32 v12, 2, v1
    v_and_b32 v13, 3, v1
    s_movk_i32 s66, 3584
    v_mul_u32_u24 v14, s66, v12
    v_lshl_add_u32 v14, v13, 4, v14
    v_lshlrev_b32 v15, 10, v12
    v_lshl_add_u32 v15, v13, 4, v15
    s_mov_b32 s8, s32
    s_mov_b32 s9, s33
    s_mov_b32 s10, 0x1c0000
    s_mov_b32 s11, 0x00020000
    s_mov_b32 s12, s34
    s_mov_b32 s13, s35
    s_mov_b32 s14, 0x1c0000
    s_mov_b32 s15, 0x00020000
    s_mov_b32 s20, s6
    s_mov_b32 s21, s7
    s_mov_b32 s22, 0x1c0000
    s_mov_b32 s23, 0x00020000
    s_cmp_lt_u32 s3, 4
    s_cbranch_scc1 L_k2_nw
    s_lshl_b32 s66, s60, 7
    s_lshl_b32 s67, s65, 5
    s_add_u32 s66, s66, s67
    s_mul_i32 s66, s66, 3584
    s_lshl_b32 s67, s61, 6
    s_add_u32 s66, s66, s67
    s_add_u32 s67, s66, 57344
    s_mul_i32 s68, s65, 6144
    s_add_u32 s68, s68, 75264
    s_add_u32 s69, s68, 0
    s_mov_b32 m0, s69
    s_nop 0
    buffer_load_dwordx4 v14, s[8:11], s66 offen lds
    s_add_u32 s69, s68, 1024
    s_mov_b32 m0, s69
    s_nop 0
    buffer_load_dwordx4 v14, s[8:11], s67 offen lds
    s_add_u32 s69, s68, 2048
    s_mov_b32 m0, s69
    s_nop 0
    buffer_load_dwordx4 v14, s[12:15], s66 offen lds
    s_add_u32 s69, s68, 3072
    s_mov_b32 m0, s69
    s_nop 0
    buffer_load_dwordx4 v14, s[12:15], s67 offen lds
    s_mul_i32 s66, s64, 112
    s_lshl_b32 s67, s65, 5
    s_add_u32 s66, s66, s67
    s_lshl_b32 s66, s66, 10
    s_lshl_b32 s67, s63, 6
    s_add_u32 s66, s66, s67
    s_add_u32 s67, s66, 16384
    s_add_u32 s69, s68, 4096
    s_mov_b32 m0, s69
    s_nop 0
    buffer_load_dwordx4 v15, s[20:23], s66 offen lds
    s_add_u32 s69, s68, 5120
    s_mov_b32 m0, s69
    s_nop 0
    buffer_load_dwordx4 v15, s[20:23], s67 offen lds
L_k2_nw:
    v_mov_b32 v52, 0
    v_mov_b32 v53, 0
    v_mov_b32 v54, 0
    v_mov_b32 v55, 0
    s_cmp_gt_u32 s3, 1
    s_cbranch_scc1 L_k2_z2
    s_cmp_eq_u32 s3, 1
    s_cbranch_scc1 L_k2_z1
    v_and_b32 v56, 31, v1
    v_lshlrev_b32 v56, 4, v56
    v_lshrrev_b32 v57, 5, v1
    s_movk_i32 s54, 4608
    v_mad_u32_u24 v56, v57, s54, v56
    ds_write_b128 v56, v[52:55] offset:33280
    s_branch L_k2_z2
L_k2_z1:
    v_and_b32 v56, 1, v1
    v_lshlrev_b32 v56, 4, v56
    v_bfe_u32 v57, v1, 1, 3
    s_movk_i32 s54, 4160
    v_mad_u32_u24 v56, v57, s54, v56
    ds_write_b128 v56, v[52:55] offset:4096
L_k2_z2:
    s_bfe_u32 s54, s3, 0x10001
    s_and_b32 s56, s3, 1
    s_lshl_b32 s57, s56, 8
    v_sub_u32 v56, 15, v5
    v_and_b32 v57, 3, v56
    v_and_b32 v58, 12, v56
    v_lshlrev_b32 v58, 1, v58
    v_lshl_add_u32 v58, v6, 4, v58
    s_movk_i32 s55, 4160
    v_mad_u32_u24 v58, v57, s55, v58
    s_mul_i32 s55, s54, 16640
    s_add_u32 s55, s55, 256
    s_sub_u32 s55, s55, s57
    v_add_u32 v32, s55, v58
    v_lshlrev_b32 v58, 5, v5
    v_lshl_add_u32 v58, v6, 4, v58
    s_mul_i32 s55, s54, 4608
    s_add_u32 s55, s55, 33568
    s_sub_u32 s55, s55, s57
    v_add_u32 v33, s55, v58
    s_lshl_b32 s55, s3, 9
    s_add_u32 s55, s55, 33792
    v_lshl_add_u32 v57, v7, 1, s55
    v_mov_b32 v192, 0
    v_mov_b32 v193, 0
    v_mov_b32 v194, 0
    v_mov_b32 v195, 0
    v_mov_b32 v196, 0
    v_mov_b32 v197, 0
    v_mov_b32 v198, 0
    v_mov_b32 v199, 0
    v_mov_b32 v200, 0
    v_mov_b32 v201, 0
    v_mov_b32 v202, 0
    v_mov_b32 v203, 0
    v_mov_b32 v204, 0
    v_mov_b32 v205, 0
    v_mov_b32 v206, 0
    v_mov_b32 v207, 0
    v_mov_b32 v208, 0
    v_mov_b32 v209, 0
    v_mov_b32 v210, 0
    v_mov_b32 v211, 0
    v_mov_b32 v212, 0
    v_mov_b32 v213, 0
    v_mov_b32 v214, 0
    v_mov_b32 v215, 0
    v_mov_b32 v216, 0
    v_mov_b32 v217, 0
    v_mov_b32 v218, 0
    v_mov_b32 v219, 0
    v_mov_b32 v220, 0
    v_mov_b32 v221, 0
    v_mov_b32 v222, 0
    v_mov_b32 v223, 0
    s_waitcnt lgkmcnt(0)
    s_lshl_b32 s55, s46, 16
    s_and_b32 s58, s46, 0xffff0000
    v_mov_b32 v58, s55
    v_mov_b32 v59, s58
    v_mov_b32 v34, s52
    v_mov_b32 v35, s53
    s_cmp_lt_u32 s3, 4
    s_cbranch_scc1 L_k2_xa
    s_waitcnt vmcnt(8)
    s_branch L_k2_xb
L_k2_xa:
    s_waitcnt vmcnt(2)
L_k2_xb:
    v_lshlrev_b32 v40, 16, v16
    v_and_b32 v41, 0xffff0000, v16
    v_sub_f32 v40, v40, v24
    v_sub_f32 v41, v41, v24
    v_cvt_pk_bf16_f32 v60, v40, v41
    v_lshlrev_b32 v40, 16, v60
    v_and_b32 v41, 0xffff0000, v60
    v_mul_f32 v40, v40, v28
    v_mul_f32 v41, v41, v28
    v_cvt_pk_bf16_f32 v60, v40, v41
    v_lshlrev_b32 v40, 16, v60
    v_and_b32 v41, 0xffff0000, v60
    v_lshlrev_b32 v42, 16, v17
    v_and_b32 v43, 0xffff0000, v17
    v_sub_f32 v42, v42, v25
    v_sub_f32 v43, v43, v25
    v_cvt_pk_bf16_f32 v62, v42, v43
    v_lshlrev_b32 v42, 16, v62
    v_and_b32 v43, 0xffff0000, v62
    v_mul_f32 v42, v42, v29
    v_mul_f32 v43, v43, v29
    v_cvt_pk_bf16_f32 v62, v42, v43
    v_lshlrev_b32 v42, 16, v62
    v_and_b32 v43, 0xffff0000, v62
    v_lshlrev_b32 v44, 16, v18
    v_and_b32 v45, 0xffff0000, v18
    v_sub_f32 v44, v44, v26
    v_sub_f32 v45, v45, v26
    v_cvt_pk_bf16_f32 v60, v44, v45
    v_lshlrev_b32 v44, 16, v60
    v_and_b32 v45, 0xffff0000, v60
    v_mul_f32 v44, v44, v30
    v_mul_f32 v45, v45, v30
    v_cvt_pk_bf16_f32 v60, v44, v45
    v_lshlrev_b32 v44, 16, v60
    v_and_b32 v45, 0xffff0000, v60
    v_lshlrev_b32 v46, 16, v19
    v_and_b32 v47, 0xffff0000, v19
    v_sub_f32 v46, v46, v27
    v_sub_f32 v47, v47, v27
    v_cvt_pk_bf16_f32 v62, v46, v47
    v_lshlrev_b32 v46, 16, v62
    v_and_b32 v47, 0xffff0000, v62
    v_mul_f32 v46, v46, v31
    v_mul_f32 v47, v47, v31
    v_cvt_pk_bf16_f32 v62, v46, v47
    v_lshlrev_b32 v46, 16, v62
    v_and_b32 v47, 0xffff0000, v62
    v_cvt_pk_f16_f32 v48, v40, v42
    v_cvt_pk_f16_f32 v49, v44, v46
    ds_write_b64 v57, v[48:49] offset:0
    v_cvt_pk_f16_f32 v50, v41, v43
    v_cvt_pk_f16_f32 v51, v45, v47
    ds_write_b64 v57, v[50:51] offset:4608
    v_pk_mul_f32 v[60:61], v[40:41], v[58:59]
    v_cvt_pk_bf16_f32 v20, v60, v61
    v_pk_mul_f32 v[62:63], v[42:43], v[58:59]
    v_cvt_pk_bf16_f32 v21, v62, v63
    v_pk_mul_f32 v[60:61], v[44:45], v[58:59]
    v_cvt_pk_bf16_f32 v22, v60, v61
    v_pk_mul_f32 v[62:63], v[46:47], v[58:59]
    v_cvt_pk_bf16_f32 v23, v62, v63
    s_cmp_lt_u32 s3, 4
    s_cbranch_scc1 L_k2_ra
    s_waitcnt vmcnt(6)
    s_branch L_k2_rb
L_k2_ra:
    s_waitcnt vmcnt(0)
L_k2_rb:
    ds_write_b128 v11, v[64:67] offset:0
    v_alignbit_b32 v72, v65, v64, 16
    v_alignbit_b32 v73, v66, v65, 16
    v_alignbit_b32 v74, v67, v66, 16
    v_alignbit_b32 v75, v68, v67, 16
    ds_write_b128 v11, v[72:75] offset:4160
    v_mov_b32 v76, v65
    v_mov_b32 v77, v66
    v_mov_b32 v78, v67
    v_mov_b32 v79, v68
    ds_write_b128 v11, v[76:79] offset:8320
    v_alignbit_b32 v80, v66, v65, 16
    v_alignbit_b32 v81, v67, v66, 16
    v_alignbit_b32 v82, v68, v67, 16
    v_alignbit_b32 v83, v69, v68, 16
    ds_write_b128 v11, v[80:83] offset:12480
    s_waitcnt lgkmcnt(0)
    s_barrier
    s_cmp_ge_u32 s3, 4
    s_cbranch_scc1 L_k2_helper
    ds_read_b128 v[96:99], v33 offset:192
    ds_read_b64 v[64:65], v32 offset:3776
    ds_read_b64 v[66:67], v32 offset:3784
    ds_read_b128 v[100:103], v33 offset:704
    ds_read_b64 v[68:69], v32 offset:3264
    ds_read_b64 v[70:71], v32 offset:3272
    ds_read_b128 v[104:107], v33 offset:1216
    ds_read_b64 v[72:73], v32 offset:2752
    ds_read_b64 v[74:75], v32 offset:2760
    ds_read_b128 v[108:111], v33 offset:1728
    ds_read_b64 v[76:77], v32 offset:2240
    ds_read_b64 v[78:79], v32 offset:2248
    ds_read_b128 v[112:115], v33 offset:2240
    ds_read_b64 v[80:81], v32 offset:1728
    ds_read_b64 v[82:83], v32 offset:1736
    ds_read_b128 v[116:119], v33 offset:2752
    ds_read_b64 v[84:85], v32 offset:1216
    ds_read_b64 v[86:87], v32 offset:1224
    ds_read_b128 v[120:123], v33 offset:3264
    ds_read_b64 v[88:89], v32 offset:704
    ds_read_b64 v[90:91], v32 offset:712
    ds_read_b128 v[124:127], v33 offset:3776
    ds_read_b64 v[92:93], v32 offset:192
    ds_read_b64 v[94:95], v32 offset:200
    s_mov_b32 s55, 0
L_k2_conv:
    s_waitcnt lgkmcnt(0)
    v_mfma_f32_16x16x32_f16 v[192:195], v[64:67], v[96:99], v[192:195]
    ds_read_b128 v[160:163], v33 offset:128
    v_mfma_f32_16x16x32_f16 v[196:199], v[64:67], v[100:103], v[196:199]
    ds_read_b64 v[128:129], v32 offset:3712
    v_mfma_f32_16x16x32_f16 v[200:203], v[64:67], v[104:107], v[200:203]
    ds_read_b64 v[130:131], v32 offset:3720
    v_mfma_f32_16x16x32_f16 v[204:207], v[64:67], v[108:111], v[204:207]
    ds_read_b128 v[164:167], v33 offset:640
    v_mfma_f32_16x16x32_f16 v[208:211], v[64:67], v[112:115], v[208:211]
    ds_read_b64 v[132:133], v32 offset:3200
    v_mfma_f32_16x16x32_f16 v[212:215], v[64:67], v[116:119], v[212:215]
    ds_read_b64 v[134:135], v32 offset:3208
    v_mfma_f32_16x16x32_f16 v[216:219], v[64:67], v[120:123], v[216:219]
    ds_read_b128 v[168:171], v33 offset:1152
    v_mfma_f32_16x16x32_f16 v[220:223], v[64:67], v[124:127], v[220:223]
    ds_read_b64 v[136:137], v32 offset:2688
    v_mfma_f32_16x16x32_f16 v[196:199], v[68:71], v[96:99], v[196:199]
    ds_read_b64 v[138:139], v32 offset:2696
    v_mfma_f32_16x16x32_f16 v[200:203], v[68:71], v[100:103], v[200:203]
    ds_read_b128 v[172:175], v33 offset:1664
    v_mfma_f32_16x16x32_f16 v[204:207], v[68:71], v[104:107], v[204:207]
    ds_read_b64 v[140:141], v32 offset:2176
    v_mfma_f32_16x16x32_f16 v[208:211], v[68:71], v[108:111], v[208:211]
    ds_read_b64 v[142:143], v32 offset:2184
    v_mfma_f32_16x16x32_f16 v[212:215], v[68:71], v[112:115], v[212:215]
    ds_read_b128 v[176:179], v33 offset:2176
    v_mfma_f32_16x16x32_f16 v[216:219], v[68:71], v[116:119], v[216:219]
    ds_read_b64 v[144:145], v32 offset:1664
    v_mfma_f32_16x16x32_f16 v[220:223], v[68:71], v[120:123], v[220:223]
    ds_read_b64 v[146:147], v32 offset:1672
    v_mfma_f32_16x16x32_f16 v[200:203], v[72:75], v[96:99], v[200:203]
    ds_read_b128 v[180:183], v33 offset:2688
    v_mfma_f32_16x16x32_f16 v[204:207], v[72:75], v[100:103], v[204:207]
    ds_read_b64 v[148:149], v32 offset:1152
    v_mfma_f32_16x16x32_f16 v[208:211], v[72:75], v[104:107], v[208:211]
    ds_read_b64 v[150:151], v32 offset:1160
    v_mfma_f32_16x16x32_f16 v[212:215], v[72:75], v[108:111], v[212:215]
    ds_read_b128 v[184:187], v33 offset:3200
    v_mfma_f32_16x16x32_f16 v[216:219], v[72:75], v[112:115], v[216:219]
    ds_read_b64 v[152:153], v32 offset:640
    v_mfma_f32_16x16x32_f16 v[220:223], v[72:75], v[116:119], v[220:223]
    ds_read_b64 v[154:155], v32 offset:648
    v_mfma_f32_16x16x32_f16 v[204:207], v[76:79], v[96:99], v[204:207]
    ds_read_b128 v[188:191], v33 offset:3712
    v_mfma_f32_16x16x32_f16 v[208:211], v[76:79], v[100:103], v[208:211]
    ds_read_b64 v[156:157], v32 offset:128
    v_mfma_f32_16x16x32_f16 v[212:215], v[76:79], v[104:107], v[212:215]
    ds_read_b64 v[158:159], v32 offset:136
    v_mfma_f32_16x16x32_f16 v[216:219], v[76:79], v[108:111], v[216:219]
    v_mfma_f32_16x16x32_f16 v[220:223], v[76:79], v[112:115], v[220:223]
    v_mfma_f32_16x16x32_f16 v[208:211], v[80:83], v[96:99], v[208:211]
    v_mfma_f32_16x16x32_f16 v[212:215], v[80:83], v[100:103], v[212:215]
    v_mfma_f32_16x16x32_f16 v[216:219], v[80:83], v[104:107], v[216:219]
    v_mfma_f32_16x16x32_f16 v[220:223], v[80:83], v[108:111], v[220:223]
    v_mfma_f32_16x16x32_f16 v[212:215], v[84:87], v[96:99], v[212:215]
    v_mfma_f32_16x16x32_f16 v[216:219], v[84:87], v[100:103], v[216:219]
    v_mfma_f32_16x16x32_f16 v[220:223], v[84:87], v[104:107], v[220:223]
    v_mfma_f32_16x16x32_f16 v[216:219], v[88:91], v[96:99], v[216:219]
    v_mfma_f32_16x16x32_f16 v[220:223], v[88:91], v[100:103], v[220:223]
    v_mfma_f32_16x16x32_f16 v[220:223], v[92:95], v[96:99], v[220:223]
    s_waitcnt lgkmcnt(0)
    v_mfma_f32_16x16x32_f16 v[192:195], v[128:131], v[160:163], v[192:195]
    ds_read_b128 v[96:99], v33 offset:64
    v_mfma_f32_16x16x32_f16 v[196:199], v[128:131], v[164:167], v[196:199]
    ds_read_b64 v[64:65], v32 offset:3648
    v_mfma_f32_16x16x32_f16 v[200:203], v[128:131], v[168:171], v[200:203]
    ds_read_b64 v[66:67], v32 offset:3656
    v_mfma_f32_16x16x32_f16 v[204:207], v[128:131], v[172:175], v[204:207]
    ds_read_b128 v[100:103], v33 offset:576
    v_mfma_f32_16x16x32_f16 v[208:211], v[128:131], v[176:179], v[208:211]
    ds_read_b64 v[68:69], v32 offset:3136
    v_mfma_f32_16x16x32_f16 v[212:215], v[128:131], v[180:183], v[212:215]
    ds_read_b64 v[70:71], v32 offset:3144
    v_mfma_f32_16x16x32_f16 v[216:219], v[128:131], v[184:187], v[216:219]
    ds_read_b128 v[104:107], v33 offset:1088
    v_mfma_f32_16x16x32_f16 v[220:223], v[128:131], v[188:191], v[220:223]
    ds_read_b64 v[72:73], v32 offset:2624
    v_mfma_f32_16x16x32_f16 v[196:199], v[132:135], v[160:163], v[196:199]
    ds_read_b64 v[74:75], v32 offset:2632
    v_mfma_f32_16x16x32_f16 v[200:203], v[132:135], v[164:167], v[200:203]
    ds_read_b128 v[108:111], v33 offset:1600
    v_mfma_f32_16x16x32_f16 v[204:207], v[132:135], v[168:171], v[204:207]
    ds_read_b64 v[76:77], v32 offset:2112
    v_mfma_f32_16x16x32_f16 v[208:211], v[132:135], v[172:175], v[208:211]
    ds_read_b64 v[78:79], v32 offset:2120
    v_mfma_f32_16x16x32_f16 v[212:215], v[132:135], v[176:179], v[212:215]
    ds_read_b128 v[112:115], v33 offset:2112
    v_mfma_f32_16x16x32_f16 v[216:219], v[132:135], v[180:183], v[216:219]
    ds_read_b64 v[80:81], v32 offset:1600
    v_mfma_f32_16x16x32_f16 v[220:223], v[132:135], v[184:187], v[220:223]
    ds_read_b64 v[82:83], v32 offset:1608
    v_mfma_f32_16x16x32_f16 v[200:203], v[136:139], v[160:163], v[200:203]
    ds_read_b128 v[116:119], v33 offset:2624
    v_mfma_f32_16x16x32_f16 v[204:207], v[136:139], v[164:167], v[204:207]
    ds_read_b64 v[84:85], v32 offset:1088
    v_mfma_f32_16x16x32_f16 v[208:211], v[136:139], v[168:171], v[208:211]
    ds_read_b64 v[86:87], v32 offset:1096
    v_mfma_f32_16x16x32_f16 v[212:215], v[136:139], v[172:175], v[212:215]
    ds_read_b128 v[120:123], v33 offset:3136
    v_mfma_f32_16x16x32_f16 v[216:219], v[136:139], v[176:179], v[216:219]
    ds_read_b64 v[88:89], v32 offset:576
    v_mfma_f32_16x16x32_f16 v[220:223], v[136:139], v[180:183], v[220:223]
    ds_read_b64 v[90:91], v32 offset:584
    v_mfma_f32_16x16x32_f16 v[204:207], v[140:143], v[160:163], v[204:207]
    ds_read_b128 v[124:127], v33 offset:3648
    v_mfma_f32_16x16x32_f16 v[208:211], v[140:143], v[164:167], v[208:211]
    ds_read_b64 v[92:93], v32 offset:64
    v_mfma_f32_16x16x32_f16 v[212:215], v[140:143], v[168:171], v[212:215]
    ds_read_b64 v[94:95], v32 offset:72
    v_mfma_f32_16x16x32_f16 v[216:219], v[140:143], v[172:175], v[216:219]
    v_mfma_f32_16x16x32_f16 v[220:223], v[140:143], v[176:179], v[220:223]
    v_mfma_f32_16x16x32_f16 v[208:211], v[144:147], v[160:163], v[208:211]
    v_mfma_f32_16x16x32_f16 v[212:215], v[144:147], v[164:167], v[212:215]
    v_mfma_f32_16x16x32_f16 v[216:219], v[144:147], v[168:171], v[216:219]
    v_mfma_f32_16x16x32_f16 v[220:223], v[144:147], v[172:175], v[220:223]
    v_mfma_f32_16x16x32_f16 v[212:215], v[148:151], v[160:163], v[212:215]
    v_mfma_f32_16x16x32_f16 v[216:219], v[148:151], v[164:167], v[216:219]
    v_mfma_f32_16x16x32_f16 v[220:223], v[148:151], v[168:171], v[220:223]
    v_mfma_f32_16x16x32_f16 v[216:219], v[152:155], v[160:163], v[216:219]
    v_mfma_f32_16x16x32_f16 v[220:223], v[152:155], v[164:167], v[220:223]
    v_mfma_f32_16x16x32_f16 v[220:223], v[156:159], v[160:163], v[220:223]
    v_subrev_u32 v32, 128, v32
    v_subrev_u32 v33, 128, v33
    s_add_u32 s55, s55, 1
    s_cmp_lt_u32 s55, 2
    s_cbranch_scc1 L_k2_conv
    s_lshl_b32 s55, s3, 13
    s_add_u32 s55, s55, 42496
    v_add_u32 v56, s55, v3
    ds_write_b128 v56, v[192:195] offset:0
    ds_write_b128 v56, v[196:199] offset:1024
    ds_write_b128 v56, v[200:203] offset:2048
    ds_write_b128 v56, v[204:207] offset:3072
    ds_write_b128 v56, v[208:211] offset:4096
    ds_write_b128 v56, v[212:215] offset:5120
    ds_write_b128 v56, v[216:219] offset:6144
    ds_write_b128 v56, v[220:223] offset:7168
    s_branch L_k2_fin
L_k2_helper:
    v_and_b32 v64, 1, v6
    v_lshrrev_b32 v65, 1, v6
    v_lshrrev_b32 v66, 2, v5
    v_and_b32 v67, 3, v5
    v_lshl_add_u32 v68, v65, 3, v66
    v_lshlrev_b32 v68, 6, v68
    v_lshl_add_u32 v68, v64, 11, v68
    v_lshl_add_u32 v68, v67, 3, v68
    v_add_u32 v68, s68, v68
    v_lshl_add_u32 v69, v65, 2, v66
    v_lshlrev_b32 v69, 6, v69
    v_lshl_add_u32 v69, v64, 5, v69
    v_lshl_add_u32 v69, v67, 3, v69
    v_add_u32 v69, s68, v69
    s_mov_b32 s54, 0x3f803f80
    v_mov_b32 v100, 0
    v_mov_b32 v101, 0
    s_lshl_b32 s66, s61, 6
    s_lshl_b32 s67, s60, 3
    s_add_u32 s66, s66, s67
    s_lshl_b32 s67, s65, 1
    s_add_u32 s66, s66, s67
    s_lshl_b32 s66, s66, 10
    s_add_u32 s66, s66, 0x100000
    s_add_u32 s67, s66, 32768
    s_lshr_b32 s69, s63, 1
    s_mul_i32 s69, s69, 112
    s_mul_i32 s70, s64, 7
    s_add_u32 s69, s69, s70
    s_lshl_b32 s70, s65, 1
    s_add_u32 s69, s69, s70
    s_lshl_b32 s69, s69, 1
    s_and_b32 s70, s63, 1
    s_add_u32 s69, s69, s70
    s_lshl_b32 s69, s69, 10
    s_add_u32 s69, s69, 0x500000
    s_waitcnt vmcnt(0)
    ds_read_b64_tr_b16 v[72:73], v68 offset:0
    ds_read_b64_tr_b16 v[74:75], v68 offset:256
    ds_read_b64_tr_b16 v[76:77], v68 offset:1024
    ds_read_b64_tr_b16 v[78:79], v68 offset:1280
    ds_read_b64_tr_b16 v[80:81], v68 offset:32
    ds_read_b64_tr_b16 v[82:83], v68 offset:288
    ds_read_b64_tr_b16 v[84:85], v68 offset:1056
    ds_read_b64_tr_b16 v[86:87], v68 offset:1312
    ds_read_b64_tr_b16 v[88:89], v69 offset:4096
    ds_read_b64_tr_b16 v[90:91], v69 offset:4608
    ds_read_b64_tr_b16 v[92:93], v69 offset:5120
    ds_read_b64_tr_b16 v[94:95], v69 offset:5632
    s_waitcnt lgkmcnt(0)
    buffer_store_dwordx4 v[88:91], v3, s[24:27], s69 offen sc1
    s_cmp_eq_u32 s65, 3
    s_cbranch_scc1 L_k2_h1
    buffer_store_dwordx4 v[92:95], v3, s[24:27], s69 offen offset:2048 sc1
L_k2_h1:
    s_cmp_ge_u32 s60, 4
    s_cbranch_scc1 L_k2_fin
    buffer_store_dwordx4 v[72:75], v3, s[24:27], s66 offen offset:0 sc1
    buffer_store_dwordx4 v[76:79], v3, s[24:27], s66 offen offset:1024 sc1
    buffer_store_dwordx4 v[80:83], v3, s[24:27], s67 offen offset:0 sc1
    buffer_store_dwordx4 v[84:87], v3, s[24:27], s67 offen offset:1024 sc1
    v_dot2_f32_bf16 v100, v72, s54, v100
    v_dot2_f32_bf16 v101, v80, s54, v101
    v_dot2_f32_bf16 v100, v73, s54, v100
    v_dot2_f32_bf16 v101, v81, s54, v101
    v_dot2_f32_bf16 v100, v74, s54, v100
    v_dot2_f32_bf16 v101, v82, s54, v101
    v_dot2_f32_bf16 v100, v75, s54, v100
    v_dot2_f32_bf16 v101, v83, s54, v101
    v_dot2_f32_bf16 v100, v76, s54, v100
    v_dot2_f32_bf16 v101, v84, s54, v101
    v_dot2_f32_bf16 v100, v77, s54, v100
    v_dot2_f32_bf16 v101, v85, s54, v101
    v_dot2_f32_bf16 v100, v78, s54, v100
    v_dot2_f32_bf16 v101, v86, s54, v101
    v_dot2_f32_bf16 v100, v79, s54, v100
    v_dot2_f32_bf16 v101, v87, s54, v101
    s_nop 2
    v_permlane32_swap_b32 v100, v101
    v_add_f32 v100, v100, v101
    s_lshl_b32 s70, s65, 8
    s_add_u32 s70, s70, 99840
    v_lshlrev_b32 v102, 2, v1
    v_add_u32 v102, s70, v102
    ds_write_b32 v102, v100
L_k2_fin:
    v_lshrrev_b32 v57, 2, v1
    v_and_b32 v58, 3, v1
    v_lshl_add_u32 v57, v58, 4, v57
    v_lshlrev_b32 v57, 4, v57
    s_lshl_b32 s55, s3, 10
    s_add_u32 s55, s55, 42496
    v_add_u32 v57, s55, v57
    s_lshl_b32 s55, s2, 13
    s_lshl_b32 s56, s3, 9
    s_add_u32 s55, s55, s56
    s_add_u32 s55, s55, 0x700000
    s_add_u32 s56, s55, 4096
    v_lshlrev_b32 v59, 1, v7
    s_mov_b32 s58, 0x05040100
    s_mov_b32 s59, 0x07060302
    s_waitcnt lgkmcnt(0)
    s_barrier
    ds_read_b128 v[64:67], v57 offset:0
    ds_read_b128 v[68:71], v57 offset:8192
    ds_read_b128 v[72:75], v57 offset:16384
    ds_read_b128 v[76:79], v57 offset:24576
    v_lshlrev_b32 v84, 16, v20
    v_and_b32 v85, 0xffff0000, v20
    v_lshlrev_b32 v92, 16, v16
    v_and_b32 v93, 0xffff0000, v16
    v_lshlrev_b32 v86, 16, v21
    v_and_b32 v87, 0xffff0000, v21
    v_lshlrev_b32 v94, 16, v17
    v_and_b32 v95, 0xffff0000, v17
    v_lshlrev_b32 v88, 16, v22
    v_and_b32 v89, 0xffff0000, v22
    v_lshlrev_b32 v96, 16, v18
    v_and_b32 v97, 0xffff0000, v18
    v_lshlrev_b32 v90, 16, v23
    v_and_b32 v91, 0xffff0000, v23
    v_lshlrev_b32 v98, 16, v19
    v_and_b32 v99, 0xffff0000, v19
    s_waitcnt lgkmcnt(0)
    v_add_f32 v100, v64, v68
    v_add_f32 v101, v72, v76
    v_add_f32 v102, v65, v69
    v_add_f32 v103, v73, v77
    v_add_f32 v104, v66, v70
    v_add_f32 v105, v74, v78
    v_add_f32 v106, v67, v71
    v_add_f32 v107, v75, v79
    v_pk_mul_f32 v[100:101], v[100:101], v[34:35]
    v_pk_mul_f32 v[102:103], v[102:103], v[34:35]
    v_pk_mul_f32 v[104:105], v[104:105], v[34:35]
    v_pk_mul_f32 v[106:107], v[106:107], v[34:35]
    v_cvt_pk_bf16_f32 v108, v100, v101
    v_cvt_pk_bf16_f32 v109, v102, v103
    v_cvt_pk_bf16_f32 v110, v104, v105
    v_cvt_pk_bf16_f32 v111, v106, v107
    v_lshlrev_b32 v100, 16, v108
    v_and_b32 v101, 0xffff0000, v108
    v_lshlrev_b32 v102, 16, v109
    v_and_b32 v103, 0xffff0000, v109
    v_lshlrev_b32 v104, 16, v110
    v_and_b32 v105, 0xffff0000, v110
    v_lshlrev_b32 v106, 16, v111
    v_and_b32 v107, 0xffff0000, v111
    v_pk_add_f32 v[100:101], v[100:101], v[84:85]
    v_pk_add_f32 v[102:103], v[102:103], v[86:87]
    v_pk_add_f32 v[104:105], v[104:105], v[88:89]
    v_pk_add_f32 v[106:107], v[106:107], v[90:91]
    v_cvt_pk_bf16_f32 v108, v100, v101
    v_cvt_pk_bf16_f32 v109, v102, v103
    v_cvt_pk_bf16_f32 v110, v104, v105
    v_cvt_pk_bf16_f32 v111, v106, v107
    v_lshlrev_b32 v100, 16, v108
    v_and_b32 v101, 0xffff0000, v108
    v_lshlrev_b32 v102, 16, v109
    v_and_b32 v103, 0xffff0000, v109
    v_lshlrev_b32 v104, 16, v110
    v_and_b32 v105, 0xffff0000, v110
    v_lshlrev_b32 v106, 16, v111
    v_and_b32 v107, 0xffff0000, v111
    v_pk_add_f32 v[100:101], v[100:101], v[92:93]
    v_pk_add_f32 v[102:103], v[102:103], v[94:95]
    v_pk_add_f32 v[104:105], v[104:105], v[96:97]
    v_pk_add_f32 v[106:107], v[106:107], v[98:99]
    v_cvt_pk_bf16_f32 v112, v100, v102
    v_cvt_pk_bf16_f32 v113, v104, v106
    v_cvt_pk_bf16_f32 v114, v101, v103
    v_cvt_pk_bf16_f32 v115, v105, v107
    buffer_store_dwordx2 v[112:113], v59, s[24:27], s55 offen sc1
    buffer_store_dwordx2 v[114:115], v59, s[24:27], s56 offen sc1
    s_cmp_lg_u32 s3, 7
    s_cbranch_scc1 L_k2_e2
    s_cmp_ge_u32 s60, 4
    s_cbranch_scc1 L_k2_e2
    v_lshlrev_b32 v120, 2, v1
    v_add_u32 v120, 99840, v120
    ds_read_b32 v121, v120 offset:0
    ds_read_b32 v122, v120 offset:256
    ds_read_b32 v123, v120 offset:512
    ds_read_b32 v124, v120 offset:768
    s_lshl_b32 s70, s61, 11
    s_lshr_b32 s71, s60, 1
    s_lshl_b32 s71, s71, 4
    s_add_u32 s70, s70, s71
    s_and_b32 s71, s60, 1
    s_lshl_b32 s71, s71, 3
    s_add_u32 s70, s70, s71
    s_add_u32 s70, s70, 0x10000
    v_lshlrev_b32 v120, 5, v1
    s_waitcnt lgkmcnt(0)
    v_add_f32 v121, v121, v122
    v_add_f32 v123, v123, v124
    v_add_f32 v121, v121, v123
    v_cvt_pk_bf16_f32 v124, v121, v121
    v_lshlrev_b32 v125, 16, v124
    v_sub_f32 v126, v121, v125
    v_cvt_pk_bf16_f32 v124, v121, v126
    v_and_b32 v125, 0xffff0000, v124
    v_sub_f32 v126, v126, v125
    v_mov_b32 v127, 0
    v_cvt_pk_bf16_f32 v125, v126, v127
    buffer_store_dwordx2 v[124:125], v120, s[24:27], s70 offen sc1
L_k2_e2:
L_k2_end:
    s_endpgm
.globl k3_kernel
.p2align 8
.type k3_kernel,@function
k3_kernel:
    s_cmp_ge_u32 s2, 256
    s_cbranch_scc1 L_k3_end
    s_load_dwordx2 s[38:39], s[0:1], 104
    v_and_b32 v1, 63, v0
    v_lshrrev_b32 v2, 6, v0
    s_nop 0
    v_readfirstlane_b32 s3, v2
    s_and_b32 s40, s2, 7
    s_lshr_b32 s42, s2, 3
    s_lshr_b32 s43, s40, 2
    s_lshl_b32 s43, s43, 3
    s_lshr_b32 s44, s42, 2
    s_add_u32 s43, s43, s44
    s_and_b32 s44, s40, 3
    s_lshl_b32 s44, s44, 2
    s_and_b32 s45, s42, 3
    s_add_u32 s44, s44, s45
    s_and_b32 s41, s3, 3
    s_lshr_b32 s46, s3, 2
    v_lshlrev_b32 v3, 4, v1
    v_and_b32 v4, 15, v1
    v_lshrrev_b32 v5, 4, v1
    s_cmp_ge_u32 s3, 4
    s_cbranch_scc1 L_k3_C
    v_lshlrev_b32 v6, 2, v5
    v_xor_b32 v6, v6, v4
    v_lshlrev_b32 v6, 4, v6
    v_lshl_add_u32 v6, v5, 12, v6
    v_add_u32 v7, 16384, v6
    v_add_u32 v21, 32768, v6
    v_add_u32 v22, 49152, v6
    s_lshl_b32 s50, s41, 16
    s_lshl_b32 s51, s43, 8
    s_add_u32 s50, s50, s51
    s_add_u32 s50, s50, 0x700000
    s_lshl_b32 s51, s41, 12
    s_mul_i32 s53, s44, 229376
    s_add_u32 s63, s53, 0x100000
    s_lshl_b32 s55, s41, 10
    s_add_u32 s53, s63, s55
    s_mul_i32 s55, s41, 5120
    s_add_u32 s55, s55, 16384
    s_waitcnt lgkmcnt(0)
    s_mov_b32 s24, s38
    s_mov_b32 s25, s39
    s_mov_b32 s26, 0x1700000
    s_mov_b32 s27, 0x00020000
    s_add_u32 s49, s51, 0
    s_mov_b32 m0, s49
    s_nop 0
    buffer_load_dwordx4 v6, s[24:27], s50 offen lds
    s_add_u32 s49, s51, 1024
    s_mov_b32 m0, s49
    s_nop 0
    buffer_load_dwordx4 v7, s[24:27], s50 offen lds
    s_add_u32 s49, s51, 2048
    s_mov_b32 m0, s49
    s_nop 0
    buffer_load_dwordx4 v21, s[24:27], s50 offen lds
    s_add_u32 s49, s51, 3072
    s_mov_b32 m0, s49
    s_nop 0
    buffer_load_dwordx4 v22, s[24:27], s50 offen lds
    s_add_u32 s50, s50, 262144
    s_mov_b32 s56, s53
    s_add_u32 s49, s55, 0
    s_mov_b32 m0, s49
    s_nop 0
    buffer_load_dwordx4 v3, s[24:27], s56 offen lds
    s_add_u32 s56, s56, 32768
    s_add_u32 s49, s55, 1024
    s_mov_b32 m0, s49
    s_nop 0
    buffer_load_dwordx4 v3, s[24:27], s56 offen lds
    s_add_u32 s56, s56, 32768
    s_add_u32 s49, s55, 2048
    s_mov_b32 m0, s49
    s_nop 0
    buffer_load_dwordx4 v3, s[24:27], s56 offen lds
    s_add_u32 s56, s56, 32768
    s_add_u32 s49, s55, 3072
    s_mov_b32 m0, s49
    s_nop 0
    buffer_load_dwordx4 v3, s[24:27], s56 offen lds
    s_add_u32 s56, s56, 32768
    s_add_u32 s49, s55, 4096
    s_mov_b32 m0, s49
    s_nop 0
    buffer_load_dwordx4 v3, s[24:27], s56 offen lds
    s_add_u32 s53, s53, 4096
    s_add_u32 s49, s51, 36864
    s_mov_b32 m0, s49
    s_nop 0
    buffer_load_dwordx4 v6, s[24:27], s50 offen lds
    s_add_u32 s49, s51, 37888
    s_mov_b32 m0, s49
    s_nop 0
    buffer_load_dwordx4 v7, s[24:27], s50 offen lds
    s_add_u32 s49, s51, 38912
    s_mov_b32 m0, s49
    s_nop 0
    buffer_load_dwordx4 v21, s[24:27], s50 offen lds
    s_add_u32 s49, s51, 39936
    s_mov_b32 m0, s49
    s_nop 0
    buffer_load_dwordx4 v22, s[24:27], s50 offen lds
    s_add_u32 s50, s50, 262144
    s_mov_b32 s56, s53
    s_add_u32 s49, s55, 36864
    s_mov_b32 m0, s49
    s_nop 0
    buffer_load_dwordx4 v3, s[24:27], s56 offen lds
    s_add_u32 s56, s56, 32768
    s_add_u32 s49, s55, 37888
    s_mov_b32 m0, s49
    s_nop 0
    buffer_load_dwordx4 v3, s[24:27], s56 offen lds
    s_add_u32 s56, s56, 32768
    s_add_u32 s49, s55, 38912
    s_mov_b32 m0, s49
    s_nop 0
    buffer_load_dwordx4 v3, s[24:27], s56 offen lds
    s_add_u32 s56, s56, 32768
    s_add_u32 s49, s55, 39936
    s_mov_b32 m0, s49
    s_nop 0
    buffer_load_dwordx4 v3, s[24:27], s56 offen lds
    s_add_u32 s56, s56, 32768
    s_add_u32 s49, s55, 40960
    s_mov_b32 m0, s49
    s_nop 0
    buffer_load_dwordx4 v3, s[24:27], s56 offen lds
    s_add_u32 s53, s53, 4096
    v_and_b32 v8, 1, v5
    v_lshrrev_b32 v9, 1, v5
    v_lshrrev_b32 v10, 2, v4
    v_and_b32 v14, 3, v4
    v_xor_b32 v11, s41, v10
    v_lshlrev_b32 v11, 6, v11
    v_lshl_add_u32 v11, v8, 5, v11
    v_lshl_add_u32 v11, v14, 3, v11
    v_lshl_add_u32 v12, v9, 3, v10
    v_lshl_add_u32 v26, v12, 8, v11
    v_and_b32 v12, 31, v1
    v_lshlrev_b32 v12, 3, v12
    v_lshrrev_b32 v13, 5, v1
    v_lshlrev_b32 v13, 4, v13
    v_lshl_add_u32 v13, v12, 2, v13
    s_lshl_b32 s49, s41, 8
    s_add_u32 s49, s49, 147456
    v_add_u32 v12, s49, v12
    s_mul_i32 s52, s44, 7
    s_xor_b32 s49, s46, 1
    s_mul_i32 s49, s49, 5
    s_add_u32 s52, s52, s49
    s_lshl_b32 s59, s52, 10
    s_add_u32 s59, s59, 0x10000
    s_add_u32 s77, s59, 4096
    s_lshl_b32 s58, s43, 1
    s_lshr_b32 s57, s41, 1
    s_add_u32 s58, s58, s57
    s_mul_i32 s58, s58, 112
    s_add_u32 s58, s58, s52
    s_lshl_b32 s58, s58, 1
    s_and_b32 s57, s41, 1
    s_add_u32 s58, s58, s57
    s_lshl_b32 s58, s58, 10
    s_add_u32 s58, s58, 0x900000
    buffer_load_dwordx4 v[80:83], v13, s[24:27], s59 offen offset:0
    buffer_load_dwordx4 v[84:87], v13, s[24:27], s59 offen offset:1024
    v_pk_mov_b32 v[40:41], 0, 0
    v_pk_mov_b32 v[42:43], 0, 0
    v_pk_mov_b32 v[44:45], 0, 0
    v_pk_mov_b32 v[46:47], 0, 0
    v_mov_b32 v24, 0x3f803f80
    v_mov_b32 v25, 0x3f803f80
    v_add_u32 v27, 73728, v26
    s_waitcnt vmcnt(11)
    s_barrier
    ds_read_b64_tr_b16 v[88:89], v26 offset:0
    ds_read_b64_tr_b16 v[90:91], v26 offset:1024
    ds_read_b64_tr_b16 v[92:93], v26 offset:4096
    ds_read_b64_tr_b16 v[94:95], v26 offset:5120
    ds_read_b64_tr_b16 v[96:97], v26 offset:8192
    ds_read_b64_tr_b16 v[98:99], v26 offset:9216
    ds_read_b64_tr_b16 v[100:101], v26 offset:12288
    ds_read_b64_tr_b16 v[102:103], v26 offset:13312
    s_add_u32 s49, s51, 73728
    s_mov_b32 m0, s49
    s_nop 0
    buffer_load_dwordx4 v6, s[24:27], s50 offen lds
    s_add_u32 s49, s51, 74752
    s_mov_b32 m0, s49
    s_nop 0
    buffer_load_dwordx4 v7, s[24:27], s50 offen lds
    s_add_u32 s49, s51, 75776
    s_mov_b32 m0, s49
    s_nop 0
    buffer_load_dwordx4 v21, s[24:27], s50 offen lds
    s_add_u32 s49, s51, 76800
    s_mov_b32 m0, s49
    s_nop 0
    buffer_load_dwordx4 v22, s[24:27], s50 offen lds
    s_add_u32 s50, s50, 262144
    s_mov_b32 s56, s53
    s_add_u32 s49, s55, 73728
    s_mov_b32 m0, s49
    s_nop 0
    buffer_load_dwordx4 v3, s[24:27], s56 offen lds
    s_add_u32 s56, s56, 32768
    s_add_u32 s49, s55, 74752
    s_mov_b32 m0, s49
    s_nop 0
    buffer_load_dwordx4 v3, s[24:27], s56 offen lds
    s_add_u32 s56, s56, 32768
    s_add_u32 s49, s55, 75776
    s_mov_b32 m0, s49
    s_nop 0
    buffer_load_dwordx4 v3, s[24:27], s56 offen lds
    s_waitcnt lgkmcnt(0)
    s_add_u32 s56, s56, 32768
    s_add_u32 s49, s55, 76800
    s_mov_b32 m0, s49
    s_nop 0
    buffer_load_dwordx4 v3, s[24:27], s56 offen lds
    v_mfma_f32_4x4x4_16b_bf16 v[40:43], v[88:89], v[88:89], v[40:43]
    v_mfma_f32_4x4x4_16b_bf16 v[44:47], v[24:25], v[88:89], v[44:47]
    s_nop 0
    v_mfma_f32_4x4x4_16b_bf16 v[40:43], v[90:91], v[90:91], v[40:43]
    s_add_u32 s56, s56, 32768
    s_add_u32 s49, s55, 77824
    s_mov_b32 m0, s49
    s_nop 0
    buffer_load_dwordx4 v3, s[24:27], s56 offen lds
    v_mfma_f32_4x4x4_16b_bf16 v[44:47], v[24:25], v[90:91], v[44:47]
    v_mfma_f32_4x4x4_16b_bf16 v[40:43], v[92:93], v[92:93], v[40:43]
    s_nop 0
    v_mfma_f32_4x4x4_16b_bf16 v[44:47], v[24:25], v[92:93], v[44:47]
    s_add_u32 s53, s53, 4096
    s_add_u32 s49, s51, 110592
    s_mov_b32 m0, s49
    s_nop 0
    buffer_load_dwordx4 v6, s[24:27], s50 offen lds
    v_mfma_f32_4x4x4_16b_bf16 v[40:43], v[94:95], v[94:95], v[40:43]
    v_mfma_f32_4x4x4_16b_bf16 v[44:47], v[24:25], v[94:95], v[44:47]
    s_nop 0
    v_mfma_f32_4x4x4_16b_bf16 v[40:43], v[96:97], v[96:97], v[40:43]
    s_add_u32 s49, s51, 111616
    s_mov_b32 m0, s49
    s_nop 0
    buffer_load_dwordx4 v7, s[24:27], s50 offen lds
    v_mfma_f32_4x4x4_16b_bf16 v[44:47], v[24:25], v[96:97], v[44:47]
    v_mfma_f32_4x4x4_16b_bf16 v[40:43], v[98:99], v[98:99], v[40:43]
    s_nop 0
    v_mfma_f32_4x4x4_16b_bf16 v[44:47], v[24:25], v[98:99], v[44:47]
    s_add_u32 s49, s51, 112640
    s_mov_b32 m0, s49
    s_nop 0
    buffer_load_dwordx4 v21, s[24:27], s50 offen lds
    v_mfma_f32_4x4x4_16b_bf16 v[40:43], v[100:101], v[100:101], v[40:43]
    v_mfma_f32_4x4x4_16b_bf16 v[44:47], v[24:25], v[100:101], v[44:47]
    s_nop 0
    v_mfma_f32_4x4x4_16b_bf16 v[40:43], v[102:103], v[102:103], v[40:43]
    s_add_u32 s49, s51, 113664
    s_mov_b32 m0, s49
    s_nop 0
    buffer_load_dwordx4 v22, s[24:27], s50 offen lds
    v_mfma_f32_4x4x4_16b_bf16 v[44:47], v[24:25], v[102:103], v[44:47]
    s_add_u32 s50, s50, 262144
    s_mov_b32 s56, s53
    s_add_u32 s49, s55, 110592
    s_mov_b32 m0, s49
    s_nop 0
    buffer_load_dwordx4 v3, s[24:27], s56 offen lds
    s_add_u32 s56, s56, 32768
    s_add_u32 s49, s55, 111616
    s_mov_b32 m0, s49
    s_nop 0
    buffer_load_dwordx4 v3, s[24:27], s56 offen lds
    s_add_u32 s56, s56, 32768
    s_add_u32 s49, s55, 112640
    s_mov_b32 m0, s49
    s_nop 0
    buffer_load_dwordx4 v3, s[24:27], s56 offen lds
    s_add_u32 s56, s56, 32768
    s_add_u32 s49, s55, 113664
    s_mov_b32 m0, s49
    s_nop 0
    buffer_load_dwordx4 v3, s[24:27], s56 offen lds
    s_add_u32 s56, s56, 32768
    s_add_u32 s49, s55, 114688
    s_mov_b32 m0, s49
    s_nop 0
    buffer_load_dwordx4 v3, s[24:27], s56 offen lds
    s_add_u32 s53, s53, 4096
    s_waitcnt vmcnt(20)
    s_barrier
    ds_read_b64_tr_b16 v[104:105], v26 offset:36864
    ds_read_b64_tr_b16 v[106:107], v26 offset:37888
    ds_read_b64_tr_b16 v[108:109], v26 offset:40960
    ds_read_b64_tr_b16 v[110:111], v26 offset:41984
    ds_read_b64_tr_b16 v[112:113], v26 offset:45056
    ds_read_b64_tr_b16 v[114:115], v26 offset:46080
    ds_read_b64_tr_b16 v[116:117], v26 offset:49152
    ds_read_b64_tr_b16 v[118:119], v26 offset:50176
    s_add_u32 s49, s51, 0
    s_mov_b32 m0, s49
    s_nop 0
    buffer_load_dwordx4 v6, s[24:27], s50 offen lds
    s_add_u32 s49, s51, 1024
    s_mov_b32 m0, s49
    s_nop 0
    buffer_load_dwordx4 v7, s[24:27], s50 offen lds
    s_add_u32 s49, s51, 2048
    s_mov_b32 m0, s49
    s_nop 0
    buffer_load_dwordx4 v21, s[24:27], s50 offen lds
    s_add_u32 s49, s51, 3072
    s_mov_b32 m0, s49
    s_nop 0
    buffer_load_dwordx4 v22, s[24:27], s50 offen lds
    s_waitcnt lgkmcnt(0)
    s_add_u32 s50, s50, 262144
    s_mov_b32 s56, s53
    s_add_u32 s49, s55, 0
    s_mov_b32 m0, s49
    s_nop 0
    buffer_load_dwordx4 v3, s[24:27], s56 offen lds
    v_mfma_f32_4x4x4_16b_bf16 v[40:43], v[104:105], v[104:105], v[40:43]
    v_mfma_f32_4x4x4_16b_bf16 v[44:47], v[24:25], v[104:105], v[44:47]
    s_nop 0
    v_mfma_f32_4x4x4_16b_bf16 v[40:43], v[106:107], v[106:107], v[40:43]
    s_add_u32 s56, s56, 32768
    s_add_u32 s49, s55, 1024
    s_mov_b32 m0, s49
    s_nop 0
    buffer_load_dwordx4 v3, s[24:27], s56 offen lds
    v_mfma_f32_4x4x4_16b_bf16 v[44:47], v[24:25], v[106:107], v[44:47]
    v_mfma_f32_4x4x4_16b_bf16 v[40:43], v[108:109], v[108:109], v[40:43]
    s_nop 0
    v_mfma_f32_4x4x4_16b_bf16 v[44:47], v[24:25], v[108:109], v[44:47]
    s_add_u32 s56, s56, 32768
    s_add_u32 s49, s55, 2048
    s_mov_b32 m0, s49
    s_nop 0
    buffer_load_dwordx4 v3, s[24:27], s56 offen lds
    v_mfma_f32_4x4x4_16b_bf16 v[40:43], v[110:111], v[110:111], v[40:43]
    v_mfma_f32_4x4x4_16b_bf16 v[44:47], v[24:25], v[110:111], v[44:47]
    s_nop 0
    v_mfma_f32_4x4x4_16b_bf16 v[40:43], v[112:113], v[112:113], v[40:43]
    s_add_u32 s56, s56, 32768
    s_add_u32 s49, s55, 3072
    s_mov_b32 m0, s49
    s_nop 0
    buffer_load_dwordx4 v3, s[24:27], s56 offen lds
    v_mfma_f32_4x4x4_16b_bf16 v[44:47], v[24:25], v[112:113], v[44:47]
    v_mfma_f32_4x4x4_16b_bf16 v[40:43], v[114:115], v[114:115], v[40:43]
    s_nop 0
    v_mfma_f32_4x4x4_16b_bf16 v[44:47], v[24:25], v[114:115], v[44:47]
    s_add_u32 s56, s56, 32768
    s_add_u32 s49, s55, 4096
    s_mov_b32 m0, s49
    s_nop 0
    buffer_load_dwordx4 v3, s[24:27], s56 offen lds
    v_mfma_f32_4x4x4_16b_bf16 v[40:43], v[116:117], v[116:117], v[40:43]
    v_mfma_f32_4x4x4_16b_bf16 v[44:47], v[24:25], v[116:117], v[44:47]
    s_nop 0
    v_mfma_f32_4x4x4_16b_bf16 v[40:43], v[118:119], v[118:119], v[40:43]
    s_add_u32 s53, s53, 4096
    v_mfma_f32_4x4x4_16b_bf16 v[44:47], v[24:25], v[118:119], v[44:47]
    s_waitcnt vmcnt(18)
    s_barrier
    ds_read_b64_tr_b16 v[120:121], v27 offset:0
    ds_read_b64_tr_b16 v[122:123], v27 offset:1024
    ds_read_b64_tr_b16 v[124:125], v27 offset:4096
    ds_read_b64_tr_b16 v[126:127], v27 offset:5120
    ds_read_b64_tr_b16 v[128:129], v27 offset:8192
    ds_read_b64_tr_b16 v[130:131], v27 offset:9216
    ds_read_b64_tr_b16 v[132:133], v27 offset:12288
    ds_read_b64_tr_b16 v[134:135], v27 offset:13312
    s_add_u32 s49, s51, 36864
    s_mov_b32 m0, s49
    s_nop 0
    buffer_load_dwordx4 v6, s[24:27], s50 offen lds
    s_add_u32 s49, s51, 37888
    s_mov_b32 m0, s49
    s_nop 0
    buffer_load_dwordx4 v7, s[24:27], s50 offen lds
    s_add_u32 s49, s51, 38912
    s_mov_b32 m0, s49
    s_nop 0
    buffer_load_dwordx4 v21, s[24:27], s50 offen lds
    s_add_u32 s49, s51, 39936
    s_mov_b32 m0, s49
    s_nop 0
    buffer_load_dwordx4 v22, s[24:27], s50 offen lds
    s_waitcnt lgkmcnt(0)
    s_add_u32 s50, s50, 262144
    s_mov_b32 s56, s53
    s_add_u32 s49, s55, 36864
    s_mov_b32 m0, s49
    s_nop 0
    buffer_load_dwordx4 v3, s[24:27], s56 offen lds
    v_mfma_f32_4x4x4_16b_bf16 v[40:43], v[120:121], v[120:121], v[40:43]
    v_mfma_f32_4x4x4_16b_bf16 v[44:47], v[24:25], v[120:121], v[44:47]
    s_nop 0
    v_mfma_f32_4x4x4_16b_bf16 v[40:43], v[122:123], v[122:123], v[40:43]
    s_add_u32 s56, s56, 32768
    s_add_u32 s49, s55, 37888
    s_mov_b32 m0, s49
    s_nop 0
    buffer_load_dwordx4 v3, s[24:27], s56 offen lds
    v_mfma_f32_4x4x4_16b_bf16 v[44:47], v[24:25], v[122:123], v[44:47]
    v_mfma_f32_4x4x4_16b_bf16 v[40:43], v[124:125], v[124:125], v[40:43]
    s_nop 0
    v_mfma_f32_4x4x4_16b_bf16 v[44:47], v[24:25], v[124:125], v[44:47]
    s_add_u32 s56, s56, 32768
    s_add_u32 s49, s55, 38912
    s_mov_b32 m0, s49
    s_nop 0
    buffer_load_dwordx4 v3, s[24:27], s56 offen lds
    v_mfma_f32_4x4x4_16b_bf16 v[40:43], v[126:127], v[126:127], v[40:43]
    v_mfma_f32_4x4x4_16b_bf16 v[44:47], v[24:25], v[126:127], v[44:47]
    s_nop 0
    v_mfma_f32_4x4x4_16b_bf16 v[40:43], v[128:129], v[128:129], v[40:43]
    s_add_u32 s56, s56, 32768
    s_add_u32 s49, s55, 39936
    s_mov_b32 m0, s49
    s_nop 0
    buffer_load_dwordx4 v3, s[24:27], s56 offen lds
    v_mfma_f32_4x4x4_16b_bf16 v[44:47], v[24:25], v[128:129], v[44:47]
    v_mfma_f32_4x4x4_16b_bf16 v[40:43], v[130:131], v[130:131], v[40:43]
    s_nop 0
    v_mfma_f32_4x4x4_16b_bf16 v[44:47], v[24:25], v[130:131], v[44:47]
    s_add_u32 s56, s56, 32768
    s_add_u32 s49, s55, 40960
    s_mov_b32 m0, s49
    s_nop 0
    buffer_load_dwordx4 v3, s[24:27], s56 offen lds
    v_mfma_f32_4x4x4_16b_bf16 v[40:43], v[132:133], v[132:133], v[40:43]
    v_mfma_f32_4x4x4_16b_bf16 v[44:47], v[24:25], v[132:133], v[44:47]
    s_nop 0
    v_mfma_f32_4x4x4_16b_bf16 v[40:43], v[134:135], v[134:135], v[40:43]
    s_add_u32 s53, s53, 4096
    v_mfma_f32_4x4x4_16b_bf16 v[44:47], v[24:25], v[134:135], v[44:47]
    s_waitcnt vmcnt(18)
    s_barrier
    ds_read_b64_tr_b16 v[136:137], v27 offset:36864
    ds_read_b64_tr_b16 v[138:139], v27 offset:37888
    ds_read_b64_tr_b16 v[140:141], v27 offset:40960
    ds_read_b64_tr_b16 v[142:143], v27 offset:41984
    ds_read_b64_tr_b16 v[144:145], v27 offset:45056
    ds_read_b64_tr_b16 v[146:147], v27 offset:46080
    ds_read_b64_tr_b16 v[148:149], v27 offset:49152
    ds_read_b64_tr_b16 v[150:151], v27 offset:50176
    s_add_u32 s49, s51, 73728
    s_mov_b32 m0, s49
    s_nop 0
    buffer_load_dwordx4 v6, s[24:27], s50 offen lds
    s_add_u32 s49, s51, 74752
    s_mov_b32 m0, s49
    s_nop 0
    buffer_load_dwordx4 v7, s[24:27], s50 offen lds
    s_add_u32 s49, s51, 75776
    s_mov_b32 m0, s49
    s_nop 0
    buffer_load_dwordx4 v21, s[24:27], s50 offen lds
    s_add_u32 s49, s51, 76800
    s_mov_b32 m0, s49
    s_nop 0
    buffer_load_dwordx4 v22, s[24:27], s50 offen lds
    s_waitcnt lgkmcnt(0)
    s_add_u32 s50, s50, 262144
    s_mov_b32 s56, s53
    s_add_u32 s49, s55, 73728
    s_mov_b32 m0, s49
    s_nop 0
    buffer_load_dwordx4 v3, s[24:27], s56 offen lds
    v_mfma_f32_4x4x4_16b_bf16 v[40:43], v[136:137], v[136:137], v[40:43]
    v_mfma_f32_4x4x4_16b_bf16 v[44:47], v[24:25], v[136:137], v[44:47]
    s_nop 0
    v_mfma_f32_4x4x4_16b_bf16 v[40:43], v[138:139], v[138:139], v[40:43]
    s_add_u32 s56, s56, 32768
    s_add_u32 s49, s55, 74752
    s_mov_b32 m0, s49
    s_nop 0
    buffer_load_dwordx4 v3, s[24:27], s56 offen lds
    v_mfma_f32_4x4x4_16b_bf16 v[44:47], v[24:25], v[138:139], v[44:47]
    v_mfma_f32_4x4x4_16b_bf16 v[40:43], v[140:141], v[140:141], v[40:43]
    s_nop 0
    v_mfma_f32_4x4x4_16b_bf16 v[44:47], v[24:25], v[140:141], v[44:47]
    s_add_u32 s56, s56, 32768
    s_add_u32 s49, s55, 75776
    s_mov_b32 m0, s49
    s_nop 0
    buffer_load_dwordx4 v3, s[24:27], s56 offen lds
    v_mfma_f32_4x4x4_16b_bf16 v[40:43], v[142:143], v[142:143], v[40:43]
    v_mfma_f32_4x4x4_16b_bf16 v[44:47], v[24:25], v[142:143], v[44:47]
    s_nop 0
    v_mfma_f32_4x4x4_16b_bf16 v[40:43], v[144:145], v[144:145], v[40:43]
    s_add_u32 s56, s56, 32768
    s_add_u32 s49, s55, 76800
    s_mov_b32 m0, s49
    s_nop 0
    buffer_load_dwordx4 v3, s[24:27], s56 offen lds
    v_mfma_f32_4x4x4_16b_bf16 v[44:47], v[24:25], v[144:145], v[44:47]
    v_mfma_f32_4x4x4_16b_bf16 v[40:43], v[146:147], v[146:147], v[40:43]
    s_nop 0
    v_mfma_f32_4x4x4_16b_bf16 v[44:47], v[24:25], v[146:147], v[44:47]
    s_add_u32 s56, s56, 32768
    s_add_u32 s49, s55, 77824
    s_mov_b32 m0, s49
    s_nop 0
    buffer_load_dwordx4 v3, s[24:27], s56 offen lds
    v_mfma_f32_4x4x4_16b_bf16 v[40:43], v[148:149], v[148:149], v[40:43]
    v_mfma_f32_4x4x4_16b_bf16 v[44:47], v[24:25], v[148:149], v[44:47]
    s_nop 0
    v_mfma_f32_4x4x4_16b_bf16 v[40:43], v[150:151], v[150:151], v[40:43]
    s_add_u32 s53, s53, 4096
    v_mfma_f32_4x4x4_16b_bf16 v[44:47], v[24:25], v[150:151], v[44:47]
    s_waitcnt vmcnt(18)
    s_barrier
    ds_read_b64_tr_b16 v[152:153], v26 offset:0
    ds_read_b64_tr_b16 v[154:155], v26 offset:1024
    ds_read_b64_tr_b16 v[156:157], v26 offset:4096
    ds_read_b64_tr_b16 v[158:159], v26 offset:5120
    ds_read_b64_tr_b16 v[160:161], v26 offset:8192
    ds_read_b64_tr_b16 v[162:163], v26 offset:9216
    ds_read_b64_tr_b16 v[164:165], v26 offset:12288
    ds_read_b64_tr_b16 v[166:167], v26 offset:13312
    s_add_u32 s49, s51, 110592
    s_mov_b32 m0, s49
    s_nop 0
    buffer_load_dwordx4 v6, s[24:27], s50 offen lds
    s_add_u32 s49, s51, 111616
    s_mov_b32 m0, s49
    s_nop 0
    buffer_load_dwordx4 v7, s[24:27], s50 offen lds
    s_add_u32 s49, s51, 112640
    s_mov_b32 m0, s49
    s_nop 0
    buffer_load_dwordx4 v21, s[24:27], s50 offen lds
    s_add_u32 s49, s51, 113664
    s_mov_b32 m0, s49
    s_nop 0
    buffer_load_dwordx4 v22, s[24:27], s50 offen lds
    s_waitcnt lgkmcnt(0)
    s_add_u32 s50, s50, 262144
    s_mov_b32 s56, s53
    s_add_u32 s49, s55, 110592
    s_mov_b32 m0, s49
    s_nop 0
    buffer_load_dwordx4 v3, s[24:27], s56 offen lds
    v_mfma_f32_4x4x4_16b_bf16 v[40:43], v[152:153], v[152:153], v[40:43]
    v_mfma_f32_4x4x4_16b_bf16 v[44:47], v[24:25], v[152:153], v[44:47]
    s_nop 0
    v_mfma_f32_4x4x4_16b_bf16 v[40:43], v[154:155], v[154:155], v[40:43]
    s_add_u32 s56, s56, 32768
    s_add_u32 s49, s55, 111616
    s_mov_b32 m0, s49
    s_nop 0
    buffer_load_dwordx4 v3, s[24:27], s56 offen lds
    v_mfma_f32_4x4x4_16b_bf16 v[44:47], v[24:25], v[154:155], v[44:47]
    v_mfma_f32_4x4x4_16b_bf16 v[40:43], v[156:157], v[156:157], v[40:43]
    s_nop 0
    v_mfma_f32_4x4x4_16b_bf16 v[44:47], v[24:25], v[156:157], v[44:47]
    s_add_u32 s56, s56, 32768
    s_add_u32 s49, s55, 112640
    s_mov_b32 m0, s49
    s_nop 0
    buffer_load_dwordx4 v3, s[24:27], s56 offen lds
    v_mfma_f32_4x4x4_16b_bf16 v[40:43], v[158:159], v[158:159], v[40:43]
    v_mfma_f32_4x4x4_16b_bf16 v[44:47], v[24:25], v[158:159], v[44:47]
    s_nop 0
    v_mfma_f32_4x4x4_16b_bf16 v[40:43], v[160:161], v[160:161], v[40:43]
    s_add_u32 s56, s56, 32768
    s_add_u32 s49, s55, 113664
    s_mov_b32 m0, s49
    s_nop 0
    buffer_load_dwordx4 v3, s[24:27], s56 offen lds
    v_mfma_f32_4x4x4_16b_bf16 v[44:47], v[24:25], v[160:161], v[44:47]
    v_mfma_f32_4x4x4_16b_bf16 v[40:43], v[162:163], v[162:163], v[40:43]
    s_nop 0
    v_mfma_f32_4x4x4_16b_bf16 v[44:47], v[24:25], v[162:163], v[44:47]
    s_add_u32 s56, s56, 32768
    s_add_u32 s49, s55, 114688
    s_mov_b32 m0, s49
    s_nop 0
    buffer_load_dwordx4 v3, s[24:27], s56 offen lds
    v_mfma_f32_4x4x4_16b_bf16 v[40:43], v[164:165], v[164:165], v[40:43]
    v_mfma_f32_4x4x4_16b_bf16 v[44:47], v[24:25], v[164:165], v[44:47]
    s_nop 0
    v_mfma_f32_4x4x4_16b_bf16 v[40:43], v[166:167], v[166:167], v[40:43]
    s_add_u32 s53, s53, 4096
    v_mfma_f32_4x4x4_16b_bf16 v[44:47], v[24:25], v[166:167], v[44:47]
    s_waitcnt vmcnt(18)
    s_barrier
    ds_read_b64_tr_b16 v[168:169], v26 offset:36864
    ds_read_b64_tr_b16 v[170:171], v26 offset:37888
    ds_read_b64_tr_b16 v[172:173], v26 offset:40960
    ds_read_b64_tr_b16 v[174:175], v26 offset:41984
    ds_read_b64_tr_b16 v[176:177], v26 offset:45056
    ds_read_b64_tr_b16 v[178:179], v26 offset:46080
    ds_read_b64_tr_b16 v[180:181], v26 offset:49152
    ds_read_b64_tr_b16 v[182:183], v26 offset:50176
    s_lshl_b32 s49, s41, 13
    s_add_u32 s56, s63, s49
    s_add_u32 s56, s56, 163840
    s_add_u32 s49, s49, 0
    s_mov_b32 m0, s49
    s_nop 0
    buffer_load_dwordx4 v3, s[24:27], s56 offen offset:0 lds
    s_waitcnt lgkmcnt(0)
    buffer_load_dwordx4 v3, s[24:27], s56 offen offset:1024 lds
    v_mfma_f32_4x4x4_16b_bf16 v[40:43], v[168:169], v[168:169], v[40:43]
    v_mfma_f32_4x4x4_16b_bf16 v[44:47], v[24:25], v[168:169], v[44:47]
    s_nop 0
    v_mfma_f32_4x4x4_16b_bf16 v[40:43], v[170:171], v[170:171], v[40:43]
    buffer_load_dwordx4 v3, s[24:27], s56 offen offset:2048 lds
    v_mfma_f32_4x4x4_16b_bf16 v[44:47], v[24:25], v[170:171], v[44:47]
    v_mfma_f32_4x4x4_16b_bf16 v[40:43], v[172:173], v[172:173], v[40:43]
    s_nop 0
    v_mfma_f32_4x4x4_16b_bf16 v[44:47], v[24:25], v[172:173], v[44:47]
    buffer_load_dwordx4 v3, s[24:27], s56 offen offset:3072 lds
    v_mfma_f32_4x4x4_16b_bf16 v[40:43], v[174:175], v[174:175], v[40:43]
    v_mfma_f32_4x4x4_16b_bf16 v[44:47], v[24:25], v[174:175], v[44:47]
    s_nop 0
    v_mfma_f32_4x4x4_16b_bf16 v[40:43], v[176:177], v[176:177], v[40:43]
    s_add_u32 s49, s49, 4096
    s_add_u32 s56, s56, 4096
    s_mov_b32 m0, s49
    s_nop 0
    buffer_load_dwordx4 v3, s[24:27], s56 offen offset:0 lds
    v_mfma_f32_4x4x4_16b_bf16 v[44:47], v[24:25], v[176:177], v[44:47]
    v_mfma_f32_4x4x4_16b_bf16 v[40:43], v[178:179], v[178:179], v[40:43]
    s_nop 0
    v_mfma_f32_4x4x4_16b_bf16 v[44:47], v[24:25], v[178:179], v[44:47]
    buffer_load_dwordx4 v3, s[24:27], s56 offen offset:1024 lds
    v_mfma_f32_4x4x4_16b_bf16 v[40:43], v[180:181], v[180:181], v[40:43]
    v_mfma_f32_4x4x4_16b_bf16 v[44:47], v[24:25], v[180:181], v[44:47]
    s_nop 0
    v_mfma_f32_4x4x4_16b_bf16 v[40:43], v[182:183], v[182:183], v[40:43]
    buffer_load_dwordx4 v3, s[24:27], s56 offen offset:2048 lds
    v_mfma_f32_4x4x4_16b_bf16 v[44:47], v[24:25], v[182:183], v[44:47]
    buffer_load_dwordx4 v3, s[24:27], s56 offen offset:3072 lds
    s_waitcnt vmcnt(17)
    s_barrier
    ds_read_b64_tr_b16 v[184:185], v27 offset:0
    ds_read_b64_tr_b16 v[186:187], v27 offset:1024
    ds_read_b64_tr_b16 v[188:189], v27 offset:4096
    ds_read_b64_tr_b16 v[190:191], v27 offset:5120
    ds_read_b64_tr_b16 v[192:193], v27 offset:8192
    ds_read_b64_tr_b16 v[194:195], v27 offset:9216
    ds_read_b64_tr_b16 v[196:197], v27 offset:12288
    ds_read_b64_tr_b16 v[198:199], v27 offset:13312
    s_lshl_b32 s49, s41, 13
    s_add_u32 s56, s63, s49
    s_add_u32 s56, s56, 196608
    s_add_u32 s49, s49, 36864
    s_mov_b32 m0, s49
    s_nop 0
    buffer_load_dwordx4 v3, s[24:27], s56 offen offset:0 lds
    s_waitcnt lgkmcnt(0)
    buffer_load_dwordx4 v3, s[24:27], s56 offen offset:1024 lds
    v_mfma_f32_4x4x4_16b_bf16 v[40:43], v[184:185], v[184:185], v[40:43]
    v_mfma_f32_4x4x4_16b_bf16 v[44:47], v[24:25], v[184:185], v[44:47]
    s_nop 0
    v_mfma_f32_4x4x4_16b_bf16 v[40:43], v[186:187], v[186:187], v[40:43]
    buffer_load_dwordx4 v3, s[24:27], s56 offen offset:2048 lds
    v_mfma_f32_4x4x4_16b_bf16 v[44:47], v[24:25], v[186:187], v[44:47]
    v_mfma_f32_4x4x4_16b_bf16 v[40:43], v[188:189], v[188:189], v[40:43]
    s_nop 0
    v_mfma_f32_4x4x4_16b_bf16 v[44:47], v[24:25], v[188:189], v[44:47]
    buffer_load_dwordx4 v3, s[24:27], s56 offen offset:3072 lds
    v_mfma_f32_4x4x4_16b_bf16 v[40:43], v[190:191], v[190:191], v[40:43]
    v_mfma_f32_4x4x4_16b_bf16 v[44:47], v[24:25], v[190:191], v[44:47]
    s_nop 0
    v_mfma_f32_4x4x4_16b_bf16 v[40:43], v[192:193], v[192:193], v[40:43]
    s_add_u32 s49, s49, 4096
    s_add_u32 s56, s56, 4096
    s_mov_b32 m0, s49
    s_nop 0
    buffer_load_dwordx4 v3, s[24:27], s56 offen offset:0 lds
    v_mfma_f32_4x4x4_16b_bf16 v[44:47], v[24:25], v[192:193], v[44:47]
    v_mfma_f32_4x4x4_16b_bf16 v[40:43], v[194:195], v[194:195], v[40:43]
    s_nop 0
    v_mfma_f32_4x4x4_16b_bf16 v[44:47], v[24:25], v[194:195], v[44:47]
    buffer_load_dwordx4 v3, s[24:27], s56 offen offset:1024 lds
    v_mfma_f32_4x4x4_16b_bf16 v[40:43], v[196:197], v[196:197], v[40:43]
    v_mfma_f32_4x4x4_16b_bf16 v[44:47], v[24:25], v[196:197], v[44:47]
    s_nop 0
    v_mfma_f32_4x4x4_16b_bf16 v[40:43], v[198:199], v[198:199], v[40:43]
    buffer_load_dwordx4 v3, s[24:27], s56 offen offset:2048 lds
    v_mfma_f32_4x4x4_16b_bf16 v[44:47], v[24:25], v[198:199], v[44:47]
    buffer_load_dwordx4 v3, s[24:27], s56 offen offset:3072 lds
    s_waitcnt vmcnt(16)
    s_barrier
    ds_read_b64_tr_b16 v[200:201], v27 offset:36864
    ds_read_b64_tr_b16 v[202:203], v27 offset:37888
    ds_read_b64_tr_b16 v[204:205], v27 offset:40960
    ds_read_b64_tr_b16 v[206:207], v27 offset:41984
    ds_read_b64_tr_b16 v[208:209], v27 offset:45056
    ds_read_b64_tr_b16 v[210:211], v27 offset:46080
    ds_read_b64_tr_b16 v[212:213], v27 offset:49152
    ds_read_b64_tr_b16 v[214:215], v27 offset:50176
    s_waitcnt lgkmcnt(0)
    v_mfma_f32_4x4x4_16b_bf16 v[40:43], v[200:201], v[200:201], v[40:43]
    v_mfma_f32_4x4x4_16b_bf16 v[44:47], v[24:25], v[200:201], v[44:47]
    s_nop 0
    v_mfma_f32_4x4x4_16b_bf16 v[40:43], v[202:203], v[202:203], v[40:43]
    v_mfma_f32_4x4x4_16b_bf16 v[44:47], v[24:25], v[202:203], v[44:47]
    s_nop 0
    v_mfma_f32_4x4x4_16b_bf16 v[40:43], v[204:205], v[204:205], v[40:43]
    v_mfma_f32_4x4x4_16b_bf16 v[44:47], v[24:25], v[204:205], v[44:47]
    s_nop 0
    v_mfma_f32_4x4x4_16b_bf16 v[40:43], v[206:207], v[206:207], v[40:43]
    v_mfma_f32_4x4x4_16b_bf16 v[44:47], v[24:25], v[206:207], v[44:47]
    s_nop 0
    v_mfma_f32_4x4x4_16b_bf16 v[40:43], v[208:209], v[208:209], v[40:43]
    v_mfma_f32_4x4x4_16b_bf16 v[44:47], v[24:25], v[208:209], v[44:47]
    s_nop 0
    v_mfma_f32_4x4x4_16b_bf16 v[40:43], v[210:211], v[210:211], v[40:43]
    v_mfma_f32_4x4x4_16b_bf16 v[44:47], v[24:25], v[210:211], v[44:47]
    s_nop 0
    v_mfma_f32_4x4x4_16b_bf16 v[40:43], v[212:213], v[212:213], v[40:43]
    v_mfma_f32_4x4x4_16b_bf16 v[44:47], v[24:25], v[212:213], v[44:47]
    s_nop 0
    v_mfma_f32_4x4x4_16b_bf16 v[40:43], v[214:215], v[214:215], v[40:43]
    v_mfma_f32_4x4x4_16b_bf16 v[44:47], v[24:25], v[214:215], v[44:47]
    v_and_b32 v10, 3, v1
    s_nop 3
    v_mov_b32 v8, v44
    v_mov_b32 v9, v40
    v_cmp_eq_u32 vcc, 1, v10
    s_nop 1
    v_cndmask_b32 v9, v9, v41, vcc
    v_cmp_eq_u32 vcc, 2, v10
    s_nop 1
    v_cndmask_b32 v9, v9, v42, vcc
    v_cmp_eq_u32 vcc, 3, v10
    s_nop 1
    v_cndmask_b32 v9, v9, v43, vcc
    v_mov_b32 v10, v8
    v_mov_b32 v11, v9
    s_nop 0
    v_permlane32_swap_b32 v8, v10
    v_permlane32_swap_b32 v9, v11
    v_add_f32 v8, v8, v10
    v_add_f32 v9, v9, v11
    v_mul_f32 v8, 0x3b000000, v8
    v_mul_f32 v9, 0x3b000000, v9
    v_fma_f32 v9, -v8, v8, v9
    v_max_f32 v9, 0, v9
    v_cvt_pk_bf16_f32 v8, v8, v8
    v_lshlrev_b32 v8, 16, v8
    v_cvt_pk_bf16_f32 v9, v9, v9
    v_lshlrev_b32 v9, 16, v9
    v_add_f32 v9, 0x3727c5ac, v9
    v_cvt_pk_bf16_f32 v9, v9, v9
    v_lshlrev_b32 v9, 16, v9
    v_sqrt_f32 v9, v9
    s_nop 0
    v_cvt_pk_bf16_f32 v9, v9, v9
    v_lshlrev_b32 v9, 16, v9
    ds_write_b64 v12, v[8:9]
    s_mov_b32 s60, 0xc0135761
    s_mov_b32 s61, 0xbdd2d3e8
    s_mov_b32 s62, 0x07060706
    v_xor_b32 v8, 0x80000000, v8
    v_perm_b32 v28, v8, v8, s62
    v_lshrrev_b32 v29, 16, v8
    v_perm_b32 v30, v8, v8, s62
    v_lshrrev_b32 v31, 16, v8
    v_rcp_f32 v10, v9
    v_mul_f32 v16, v9, v9
    v_mul_f32 v18, s60, v10
    v_mul_f32 v14, v10, v10
    v_mul_f32 v14, v14, v10
    v_mul_f32 v20, s61, v14
    s_mov_b32 s48, 8
    s_mov_b32 s47, 0
    v_mov_b32 v23, v3
    s_waitcnt lgkmcnt(0) vmcnt(0)
    s_barrier
L_k3_LM:
    ds_read_b128 v[48:51], v23 offset:0
    ds_read_b128 v[52:55], v23 offset:1024
    ds_read_b128 v[56:59], v23 offset:2048
    ds_read_b128 v[60:63], v23 offset:3072
    ds_read_b128 v[64:67], v23 offset:4096
    ds_read_b128 v[68:71], v23 offset:5120
    s_waitcnt lgkmcnt(5)
    v_mfma_f32_32x32x16_bf16 v[32:47], v[48:51], v[88:91], 0
    ds_read_b128 v[72:75], v23 offset:6144
    s_waitcnt lgkmcnt(5)
    v_mfma_f32_32x32x16_bf16 v[32:47], v[52:55], v[92:95], v[32:47]
    ds_read_b128 v[76:79], v23 offset:7168
    s_waitcnt lgkmcnt(5)
    v_mfma_f32_32x32x16_bf16 v[32:47], v[56:59], v[96:99], v[32:47]
    ds_read_b128 v[48:51], v23 offset:8192
    s_waitcnt lgkmcnt(5)
    v_mfma_f32_32x32x16_bf16 v[32:47], v[60:63], v[100:103], v[32:47]
    ds_read_b128 v[52:55], v23 offset:9216
    s_waitcnt lgkmcnt(5)
    v_mfma_f32_32x32x16_bf16 v[32:47], v[64:67], v[104:107], v[32:47]
    ds_read_b128 v[56:59], v23 offset:10240
    s_waitcnt lgkmcnt(5)
    v_mfma_f32_32x32x16_bf16 v[32:47], v[68:71], v[108:111], v[32:47]
    ds_read_b128 v[60:63], v23 offset:11264
    s_waitcnt lgkmcnt(5)
    v_mfma_f32_32x32x16_bf16 v[32:47], v[72:75], v[112:115], v[32:47]
    ds_read_b128 v[64:67], v23 offset:12288
    s_waitcnt lgkmcnt(5)
    v_mfma_f32_32x32x16_bf16 v[32:47], v[76:79], v[116:119], v[32:47]
    ds_read_b128 v[68:71], v23 offset:13312
    s_waitcnt lgkmcnt(5)
    v_mfma_f32_32x32x16_bf16 v[32:47], v[48:51], v[120:123], v[32:47]
    ds_read_b128 v[72:75], v23 offset:14336
    s_waitcnt lgkmcnt(5)
    v_mfma_f32_32x32x16_bf16 v[32:47], v[52:55], v[124:127], v[32:47]
    ds_read_b128 v[76:79], v23 offset:15360
    s_waitcnt lgkmcnt(5)
    v_mfma_f32_32x32x16_bf16 v[32:47], v[56:59], v[128:131], v[32:47]
    ds_read_b128 v[48:51], v23 offset:16384
    s_waitcnt lgkmcnt(5)
    v_mfma_f32_32x32x16_bf16 v[32:47], v[60:63], v[132:135], v[32:47]
    ds_read_b128 v[52:55], v23 offset:17408
    s_waitcnt lgkmcnt(5)
    v_mfma_f32_32x32x16_bf16 v[32:47], v[64:67], v[136:139], v[32:47]
    ds_read_b128 v[56:59], v23 offset:18432
    s_waitcnt lgkmcnt(5)
    v_mfma_f32_32x32x16_bf16 v[32:47], v[68:71], v[140:143], v[32:47]
    ds_read_b128 v[60:63], v23 offset:19456
    s_waitcnt lgkmcnt(5)
    v_mfma_f32_32x32x16_bf16 v[32:47], v[72:75], v[144:147], v[32:47]
    ds_read_b128 v[64:67], v23 offset:20480
    s_waitcnt lgkmcnt(5)
    v_mfma_f32_32x32x16_bf16 v[32:47], v[76:79], v[148:151], v[32:47]
    ds_read_b128 v[68:71], v23 offset:21504
    s_waitcnt lgkmcnt(5)
    v_mfma_f32_32x32x16_bf16 v[32:47], v[48:51], v[152:155], v[32:47]
    ds_read_b128 v[72:75], v23 offset:22528
    s_waitcnt lgkmcnt(5)
    v_mfma_f32_32x32x16_bf16 v[32:47], v[52:55], v[156:159], v[32:47]
    ds_read_b128 v[76:79], v23 offset:23552
    s_waitcnt lgkmcnt(5)
    v_mfma_f32_32x32x16_bf16 v[32:47], v[56:59], v[160:163], v[32:47]
    ds_read_b128 v[48:51], v23 offset:24576
    s_waitcnt lgkmcnt(5)
    v_mfma_f32_32x32x16_bf16 v[32:47], v[60:63], v[164:167], v[32:47]
    ds_read_b128 v[52:55], v23 offset:25600
    s_waitcnt lgkmcnt(5)
    v_mfma_f32_32x32x16_bf16 v[32:47], v[64:67], v[168:171], v[32:47]
    ds_read_b128 v[56:59], v23 offset:26624
    s_waitcnt lgkmcnt(5)
    v_mfma_f32_32x32x16_bf16 v[32:47], v[68:71], v[172:175], v[32:47]
    ds_read_b128 v[60:63], v23 offset:27648
    s_waitcnt lgkmcnt(5)
    v_mfma_f32_32x32x16_bf16 v[32:47], v[72:75], v[176:179], v[32:47]
    ds_read_b128 v[64:67], v23 offset:28672
    s_waitcnt lgkmcnt(5)
    v_mfma_f32_32x32x16_bf16 v[32:47], v[76:79], v[180:183], v[32:47]
    ds_read_b128 v[68:71], v23 offset:29696
    s_waitcnt lgkmcnt(5)
    v_mfma_f32_32x32x16_bf16 v[32:47], v[48:51], v[184:187], v[32:47]
    ds_read_b128 v[72:75], v23 offset:30720
    s_waitcnt lgkmcnt(5)
    v_mfma_f32_32x32x16_bf16 v[32:47], v[52:55], v[188:191], v[32:47]
    ds_read_b128 v[76:79], v23 offset:31744
    s_waitcnt lgkmcnt(5)
    v_mfma_f32_32x32x16_bf16 v[32:47], v[56:59], v[192:195], v[32:47]
    s_waitcnt lgkmcnt(4)
    v_mfma_f32_32x32x16_bf16 v[32:47], v[60:63], v[196:199], v[32:47]
    s_waitcnt lgkmcnt(3)
    v_mfma_f32_32x32x16_bf16 v[32:47], v[64:67], v[200:203], v[32:47]
    s_waitcnt lgkmcnt(2)
    v_mfma_f32_32x32x16_bf16 v[32:47], v[68:71], v[204:207], v[32:47]
    s_waitcnt lgkmcnt(1)
    v_mfma_f32_32x32x16_bf16 v[32:47], v[72:75], v[208:211], v[32:47]
    s_waitcnt lgkmcnt(0)
    v_mfma_f32_32x32x16_bf16 v[32:47], v[76:79], v[212:215], v[32:47]
    v_add_u32 v23, 36864, v23
    s_cmp_eq_u32 s47, 1
    s_cbranch_scc1 L_k3_epi
    v_mfma_f32_32x32x16_bf16 v[220:235], v[80:83], v[28:31], v[32:47]
    s_mov_b32 s47, 1
    s_branch L_k3_LM
L_k3_C:
    v_and_b32 v8, 1, v5
    v_lshrrev_b32 v9, 1, v5
    v_lshrrev_b32 v10, 2, v4
    v_and_b32 v14, 3, v4
    v_xor_b32 v11, s41, v10
    v_lshlrev_b32 v11, 6, v11
    v_lshl_add_u32 v11, v8, 5, v11
    v_lshl_add_u32 v11, v14, 3, v11
    v_lshl_add_u32 v12, v9, 3, v10
    v_lshl_add_u32 v26, v12, 8, v11
    v_and_b32 v12, 31, v1
    v_lshlrev_b32 v12, 3, v12
    v_lshrrev_b32 v13, 5, v1
    v_lshlrev_b32 v13, 4, v13
    v_lshl_add_u32 v13, v12, 2, v13
    s_lshl_b32 s49, s41, 8
    s_add_u32 s49, s49, 147456
    v_add_u32 v12, s49, v12
    s_mul_i32 s52, s44, 7
    s_xor_b32 s49, s46, 1
    s_mul_i32 s49, s49, 5
    s_add_u32 s52, s52, s49
    s_lshl_b32 s59, s52, 10
    s_add_u32 s59, s59, 0x10000
    s_add_u32 s77, s59, 4096
    s_lshl_b32 s58, s43, 1
    s_lshr_b32 s57, s41, 1
    s_add_u32 s58, s58, s57
    s_mul_i32 s58, s58, 112
    s_add_u32 s58, s58, s52
    s_lshl_b32 s58, s58, 1
    s_and_b32 s57, s41, 1
    s_add_u32 s58, s58, s57
    s_lshl_b32 s58, s58, 10
    s_add_u32 s58, s58, 0x900000
    v_add_u32 v27, 16384, v3
    v_pk_mov_b32 v[32:33], 0, 0
    v_pk_mov_b32 v[34:35], 0, 0
    v_pk_mov_b32 v[36:37], 0, 0
    v_pk_mov_b32 v[38:39], 0, 0
    v_pk_mov_b32 v[40:41], 0, 0
    v_pk_mov_b32 v[42:43], 0, 0
    v_pk_mov_b32 v[44:45], 0, 0
    v_pk_mov_b32 v[46:47], 0, 0
    v_pk_mov_b32 v[48:49], 0, 0
    v_pk_mov_b32 v[50:51], 0, 0
    v_pk_mov_b32 v[52:53], 0, 0
    v_pk_mov_b32 v[54:55], 0, 0
    v_pk_mov_b32 v[56:57], 0, 0
    v_pk_mov_b32 v[58:59], 0, 0
    v_pk_mov_b32 v[60:61], 0, 0
    v_pk_mov_b32 v[62:63], 0, 0
    v_pk_mov_b32 v[64:65], 0, 0
    v_pk_mov_b32 v[66:67], 0, 0
    v_pk_mov_b32 v[68:69], 0, 0
    v_pk_mov_b32 v[70:71], 0, 0
    v_pk_mov_b32 v[72:73], 0, 0
    v_pk_mov_b32 v[74:75], 0, 0
    v_pk_mov_b32 v[76:77], 0, 0
    v_pk_mov_b32 v[78:79], 0, 0
    v_pk_mov_b32 v[80:81], 0, 0
    v_pk_mov_b32 v[82:83], 0, 0
    v_pk_mov_b32 v[84:85], 0, 0
    v_pk_mov_b32 v[86:87], 0, 0
    v_pk_mov_b32 v[88:89], 0, 0
    v_pk_mov_b32 v[90:91], 0, 0
    v_pk_mov_b32 v[92:93], 0, 0
    v_pk_mov_b32 v[94:95], 0, 0
    v_pk_mov_b32 v[96:97], 0, 0
    v_pk_mov_b32 v[98:99], 0, 0
    v_pk_mov_b32 v[100:101], 0, 0
    v_pk_mov_b32 v[102:103], 0, 0
    v_pk_mov_b32 v[104:105], 0, 0
    v_pk_mov_b32 v[106:107], 0, 0
    v_pk_mov_b32 v[108:109], 0, 0
    v_pk_mov_b32 v[110:111], 0, 0
    v_pk_mov_b32 v[136:137], 0, 0
    v_pk_mov_b32 v[138:139], 0, 0
    v_pk_mov_b32 v[140:141], 0, 0
    v_pk_mov_b32 v[142:143], 0, 0
    v_pk_mov_b32 v[144:145], 0, 0
    v_pk_mov_b32 v[146:147], 0, 0
    v_pk_mov_b32 v[148:149], 0, 0
    v_pk_mov_b32 v[150:151], 0, 0
    v_pk_mov_b32 v[152:153], 0, 0
    v_pk_mov_b32 v[154:155], 0, 0
    v_pk_mov_b32 v[156:157], 0, 0
    v_pk_mov_b32 v[158:159], 0, 0
    s_mov_b32 s54, 0
    s_mov_b32 s48, 0
    s_waitcnt lgkmcnt(0)
    s_mov_b32 s24, s38
    s_mov_b32 s25, s39
    s_mov_b32 s26, 0x1700000
    s_mov_b32 s27, 0x00020000
L_k3_CL:
    v_add_u32 v24, s54, v26
    v_add_u32 v25, s54, v27
    s_add_u32 s54, s54, 36864
    s_cmp_eq_u32 s54, 147456
    s_cselect_b32 s54, 0, s54
    s_barrier
    v_mfma_f32_32x32x16_bf16 v[32:47], v[140:143], v[136:139], v[32:47]
    ds_read_b64_tr_b16 v[112:113], v24 offset:0
    ds_read_b64_tr_b16 v[114:115], v24 offset:1024
    v_mfma_f32_32x32x16_bf16 v[48:63], v[144:147], v[136:139], v[48:63]
    ds_read_b128 v[116:119], v25 offset:0
    ds_read_b128 v[120:123], v25 offset:1024
    v_mfma_f32_32x32x16_bf16 v[64:79], v[148:151], v[136:139], v[64:79]
    ds_read_b128 v[124:127], v25 offset:2048
    ds_read_b128 v[128:131], v25 offset:3072
    v_mfma_f32_32x32x16_bf16 v[80:95], v[152:155], v[136:139], v[80:95]
    ds_read_b128 v[132:135], v25 offset:4096
    v_mfma_f32_32x32x16_bf16 v[96:111], v[156:159], v[136:139], v[96:111]
    s_waitcnt lgkmcnt(4)
    v_mfma_f32_32x32x16_bf16 v[32:47], v[116:119], v[112:115], v[32:47]
    ds_read_b64_tr_b16 v[136:137], v24 offset:4096
    ds_read_b64_tr_b16 v[138:139], v24 offset:5120
    s_waitcnt lgkmcnt(5)
    v_mfma_f32_32x32x16_bf16 v[48:63], v[120:123], v[112:115], v[48:63]
    ds_read_b128 v[140:143], v25 offset:5120
    ds_read_b128 v[144:147], v25 offset:6144
    s_waitcnt lgkmcnt(6)
    v_mfma_f32_32x32x16_bf16 v[64:79], v[124:127], v[112:115], v[64:79]
    ds_read_b128 v[148:151], v25 offset:7168
    ds_read_b128 v[152:155], v25 offset:8192
    s_waitcnt lgkmcnt(7)
    v_mfma_f32_32x32x16_bf16 v[80:95], v[128:131], v[112:115], v[80:95]
    ds_read_b128 v[156:159], v25 offset:9216
    s_waitcnt lgkmcnt(7)
    v_mfma_f32_32x32x16_bf16 v[96:111], v[132:135], v[112:115], v[96:111]
    s_waitcnt lgkmcnt(4)
    v_mfma_f32_32x32x16_bf16 v[32:47], v[140:143], v[136:139], v[32:47]
    ds_read_b64_tr_b16 v[112:113], v24 offset:8192
    ds_read_b64_tr_b16 v[114:115], v24 offset:9216
    s_waitcnt lgkmcnt(5)
    v_mfma_f32_32x32x16_bf16 v[48:63], v[144:147], v[136:139], v[48:63]
    ds_read_b128 v[116:119], v25 offset:10240
    ds_read_b128 v[120:123], v25 offset:11264
    s_waitcnt lgkmcnt(6)
    v_mfma_f32_32x32x16_bf16 v[64:79], v[148:151], v[136:139], v[64:79]
    ds_read_b128 v[124:127], v25 offset:12288
    ds_read_b128 v[128:131], v25 offset:13312
    s_waitcnt lgkmcnt(7)
    v_mfma_f32_32x32x16_bf16 v[80:95], v[152:155], v[136:139], v[80:95]
    ds_read_b128 v[132:135], v25 offset:14336
    s_waitcnt lgkmcnt(7)
    v_mfma_f32_32x32x16_bf16 v[96:111], v[156:159], v[136:139], v[96:111]
    s_waitcnt lgkmcnt(4)
    v_mfma_f32_32x32x16_bf16 v[32:47], v[116:119], v[112:115], v[32:47]
    ds_read_b64_tr_b16 v[136:137], v24 offset:12288
    ds_read_b64_tr_b16 v[138:139], v24 offset:13312
    s_waitcnt lgkmcnt(5)
    v_mfma_f32_32x32x16_bf16 v[48:63], v[120:123], v[112:115], v[48:63]
    ds_read_b128 v[140:143], v25 offset:15360
    ds_read_b128 v[144:147], v25 offset:16384
    s_waitcnt lgkmcnt(6)
    v_mfma_f32_32x32x16_bf16 v[64:79], v[124:127], v[112:115], v[64:79]
    ds_read_b128 v[148:151], v25 offset:17408
    ds_read_b128 v[152:155], v25 offset:18432
    s_waitcnt lgkmcnt(7)
    v_mfma_f32_32x32x16_bf16 v[80:95], v[128:131], v[112:115], v[80:95]
    ds_read_b128 v[156:159], v25 offset:19456
    s_waitcnt lgkmcnt(7)
    v_mfma_f32_32x32x16_bf16 v[96:111], v[132:135], v[112:115], v[96:111]
    s_cmp_eq_u32 s48, 5
    s_cbranch_scc1 L_k3_csld
L_k3_csback:
    s_add_u32 s48, s48, 1
    s_cmp_lt_u32 s48, 8
    s_waitcnt lgkmcnt(0)
    s_cbranch_scc1 L_k3_CL
    v_mfma_f32_32x32x16_bf16 v[32:47], v[140:143], v[136:139], v[32:47]
    v_mfma_f32_32x32x16_bf16 v[48:63], v[144:147], v[136:139], v[48:63]
    v_mfma_f32_32x32x16_bf16 v[64:79], v[148:151], v[136:139], v[64:79]
    v_mfma_f32_32x32x16_bf16 v[80:95], v[152:155], v[136:139], v[80:95]
    v_mfma_f32_32x32x16_bf16 v[96:111], v[156:159], v[136:139], v[96:111]
    s_barrier
    ds_read_b64 v[8:9], v12
    s_waitcnt lgkmcnt(0) vmcnt(0)
    s_mov_b32 s60, 0xc0135761
    s_mov_b32 s61, 0xbdd2d3e8
    s_mov_b32 s62, 0x07060706
    v_xor_b32 v8, 0x80000000, v8
    v_perm_b32 v28, v8, v8, s62
    v_lshrrev_b32 v29, 16, v8
    v_perm_b32 v30, v8, v8, s62
    v_lshrrev_b32 v31, 16, v8
    v_rcp_f32 v10, v9
    v_mul_f32 v16, v9, v9
    v_mul_f32 v18, s60, v10
    v_mul_f32 v14, v10, v10
    v_mul_f32 v14, v14, v10
    v_mul_f32 v20, s61, v14
    s_mov_b32 s48, 0
    s_setprio 3
    v_mfma_f32_32x32x16_bf16 v[220:235], v[160:163], v[28:31], v[32:47]
L_k3_epi:
    s_nop 11
    v_mul_f32 v236, v220, v220
    v_mul_f32 v237, v221, v221
    v_mul_f32 v238, v222, v222
    v_mul_f32 v239, v223, v223
    v_mul_f32 v240, v224, v224
    v_mul_f32 v241, v225, v225
    v_mul_f32 v242, v226, v226
    v_mul_f32 v243, v227, v227
    v_fma_f32 v236, v236, v20, v18
    v_fma_f32 v237, v237, v20, v18
    v_fma_f32 v238, v238, v20, v18
    v_fma_f32 v239, v239, v20, v18
    v_fma_f32 v240, v240, v20, v18
    v_fma_f32 v241, v241, v20, v18
    v_fma_f32 v242, v242, v20, v18
    v_fma_f32 v243, v243, v20, v18
    v_mul_f32 v236, v236, v220
    v_mul_f32 v237, v237, v221
    v_mul_f32 v238, v238, v222
    v_mul_f32 v239, v239, v223
    v_mul_f32 v240, v240, v224
    v_mul_f32 v241, v241, v225
    v_mul_f32 v242, v242, v226
    v_mul_f32 v243, v243, v227
    v_mul_f32 v244, v228, v220
    v_mul_f32 v245, v229, v221
    v_mul_f32 v246, v230, v222
    v_mul_f32 v247, v231, v223
    v_mul_f32 v248, v232, v224
    v_mul_f32 v249, v233, v225
    v_mul_f32 v250, v234, v226
    v_mul_f32 v251, v235, v227
    s_add_u32 s48, s48, 1
    s_cmp_eq_u32 s48, 1
    s_cbranch_scc1 L_k3_m1
    s_cmp_eq_u32 s48, 2
    s_cbranch_scc1 L_k3_m2
    s_cmp_eq_u32 s48, 3
    s_cbranch_scc1 L_k3_m3
    s_cmp_eq_u32 s48, 4
    s_cbranch_scc1 L_k3_m4
    s_cmp_eq_u32 s48, 9
    s_cbranch_scc1 L_k3_m9
L_k3_mb:
    v_exp_f32 v236, v236
    v_exp_f32 v237, v237
    v_exp_f32 v238, v238
    v_exp_f32 v239, v239
    v_exp_f32 v240, v240
    v_exp_f32 v241, v241
    v_exp_f32 v242, v242
    v_exp_f32 v243, v243
    v_fma_f32 v236, v236, v16, v16
    v_fma_f32 v237, v237, v16, v16
    v_fma_f32 v238, v238, v16, v16
    v_fma_f32 v239, v239, v16, v16
    v_fma_f32 v240, v240, v16, v16
    v_fma_f32 v241, v241, v16, v16
    v_fma_f32 v242, v242, v16, v16
    v_fma_f32 v243, v243, v16, v16
    v_rcp_f32 v236, v236
    v_rcp_f32 v237, v237
    v_rcp_f32 v238, v238
    v_rcp_f32 v239, v239
    v_rcp_f32 v240, v240
    v_rcp_f32 v241, v241
    v_rcp_f32 v242, v242
    v_rcp_f32 v243, v243
    v_mul_f32 v244, v244, v236
    v_mul_f32 v245, v245, v237
    v_mul_f32 v246, v246, v238
    v_mul_f32 v247, v247, v239
    v_mul_f32 v248, v248, v240
    v_mul_f32 v249, v249, v241
    v_mul_f32 v250, v250, v242
    v_mul_f32 v251, v251, v243
    v_cvt_pk_bf16_f32 v252, v244, v245
    v_cvt_pk_bf16_f32 v253, v246, v247
    v_cvt_pk_bf16_f32 v254, v248, v249
    v_cvt_pk_bf16_f32 v255, v250, v251
    buffer_store_dwordx4 v[252:255], v3, s[24:27], s58 offen sc1
    s_add_u32 s58, s58, 2048
    s_cmp_lt_u32 s48, 5
    s_cbranch_scc1 L_k3_epi
    s_cmp_eq_u32 s48, 9
    s_cbranch_scc1 L_k3_epi
L_k3_end:
    s_endpgm
L_k3_m1:
    v_mfma_f32_32x32x16_bf16 v[220:235], v[164:167], v[28:31], v[48:63]
    s_branch L_k3_mb
L_k3_m2:
    s_nop 8
    v_mfma_f32_32x32x16_bf16 v[220:235], v[168:171], v[28:31], v[64:79]
    s_branch L_k3_mb
L_k3_m3:
    s_nop 8
    v_mfma_f32_32x32x16_bf16 v[220:235], v[172:175], v[28:31], v[80:95]
    s_branch L_k3_mb
L_k3_m4:
    s_nop 8
    v_mfma_f32_32x32x16_bf16 v[220:235], v[176:179], v[28:31], v[96:111]
    s_branch L_k3_mb
L_k3_m9:
    s_nop 8
    v_mfma_f32_32x32x16_bf16 v[220:235], v[84:87], v[28:31], v[32:47]
    s_branch L_k3_mb
L_k3_csld:
    buffer_load_dwordx4 v[160:163], v13, s[24:27], s59 offen offset:0
    buffer_load_dwordx4 v[164:167], v13, s[24:27], s59 offen offset:1024
    buffer_load_dwordx4 v[168:171], v13, s[24:27], s59 offen offset:2048
    buffer_load_dwordx4 v[172:175], v13, s[24:27], s59 offen offset:3072
    buffer_load_dwordx4 v[176:179], v13, s[24:27], s77 offen offset:0
    s_branch L_k3_csback
.globl k4_kernel
.p2align 8
.type k4_kernel,@function
k4_kernel:
    s_cmp_ge_u32 s2, 256
    s_cbranch_scc1 L_k4_end
    s_load_dwordx2 s[38:39], s[0:1], 104
    s_load_dwordx2 s[36:37], s[0:1], 88
    v_and_b32 v1, 63, v0
    v_lshrrev_b32 v2, 6, v0
    s_nop 0
    v_readfirstlane_b32 s3, v2
    s_and_b32 s40, s2, 7
    s_lshr_b32 s42, s2, 3
    s_lshl_b32 s43, s40, 2
    s_lshr_b32 s44, s42, 3
    s_add_u32 s43, s43, s44
    s_and_b32 s44, s42, 7
    s_and_b32 s41, s3, 3
    v_lshlrev_b32 v3, 4, v1
    s_mov_b32 s48, 0
    s_cmp_ge_u32 s3, 4
    s_cbranch_scc1 L_k4_cons
    s_lshl_b32 s45, s41, 11
    s_mul_i32 s46, s43, 229376
    s_add_u32 s46, s46, s45
    s_add_u32 s46, s46, 0x900000
    s_mul_i32 s47, s44, 229376
    s_add_u32 s47, s47, s45
    s_add_u32 s47, s47, 0x500000
    s_add_u32 s50, s45, 0
    s_add_u32 s51, s45, 81920
    s_add_u32 s52, s45, 81920
    s_add_u32 s53, s45, 147456
    v_lshrrev_b32 v4, 3, v1
    v_and_b32 v5, 7, v1
    v_and_b32 v6, 3, v4
    v_lshlrev_b32 v6, 1, v6
    v_xor_b32 v6, v6, v5
    v_lshlrev_b32 v6, 4, v6
    v_lshl_add_u32 v6, v4, 12, v6
    s_lshl_b32 s54, s44, 18
    s_lshl_b32 s55, s41, 16
    s_add_u32 s54, s54, s55
    s_lshl_b32 s55, s43, 7
    s_add_u32 s54, s54, s55
    s_add_u32 s54, s54, 0x700000
    s_add_u32 s55, s45, 147456
    s_waitcnt lgkmcnt(0)
    s_mov_b32 s24, s38
    s_mov_b32 s25, s39
    s_mov_b32 s26, 0x1700000
    s_mov_b32 s27, 0x00020000
    s_mov_b32 m0, s55
    s_nop 0
    buffer_load_dwordx4 v6, s[24:27], s54 offen lds
    s_add_u32 s55, s55, 1024
    s_add_u32 s54, s54, 32768
    s_mov_b32 m0, s55
    s_nop 0
    buffer_load_dwordx4 v6, s[24:27], s54 offen lds
L_k4_init:
    s_mov_b32 m0, s50
    s_nop 0
    buffer_load_dwordx4 v3, s[24:27], s47 offen lds
    buffer_load_dwordx4 v3, s[24:27], s47 offen offset:1024 lds
    s_mov_b32 m0, s51
    s_add_u32 s47, s47, 8192
    s_add_u32 s50, s50, 8192
    buffer_load_dwordx4 v3, s[24:27], s46 offen lds
    buffer_load_dwordx4 v3, s[24:27], s46 offen offset:1024 lds
    s_add_u32 s46, s46, 8192
    s_add_u32 s51, s51, 8192
    s_cmp_eq_u32 s50, s52
    s_cselect_b32 s56, 81920, 0
    s_sub_u32 s50, s50, s56
    s_cmp_eq_u32 s51, s53
    s_cselect_b32 s56, 65536, 0
    s_sub_u32 s51, s51, s56
    s_add_u32 s48, s48, 1
    s_cmp_lt_u32 s48, 6
    s_cbranch_scc1 L_k4_init
    s_mov_b32 s48, 0
L_k4_ll:
    s_waitcnt vmcnt(20)
    s_barrier
    s_mov_b32 m0, s50
    s_nop 0
    buffer_load_dwordx4 v3, s[24:27], s47 offen lds
    buffer_load_dwordx4 v3, s[24:27], s47 offen offset:1024 lds
    s_mov_b32 m0, s51
    s_add_u32 s47, s47, 8192
    s_add_u32 s50, s50, 8192
    buffer_load_dwordx4 v3, s[24:27], s46 offen lds
    buffer_load_dwordx4 v3, s[24:27], s46 offen offset:1024 lds
    s_add_u32 s46, s46, 8192
    s_add_u32 s51, s51, 8192
    s_cmp_eq_u32 s50, s52
    s_cselect_b32 s56, 81920, 0
    s_sub_u32 s50, s50, s56
    s_cmp_eq_u32 s51, s53
    s_cselect_b32 s56, 65536, 0
    s_sub_u32 s51, s51, s56
    s_add_u32 s48, s48, 1
    s_cmp_lt_u32 s48, 22
    s_cbranch_scc1 L_k4_ll
    s_waitcnt vmcnt(20)
    s_barrier
    s_waitcnt vmcnt(16)
    s_barrier
    s_waitcnt vmcnt(12)
    s_barrier
    s_waitcnt vmcnt(8)
    s_barrier
    s_waitcnt vmcnt(4)
    s_barrier
    s_waitcnt vmcnt(0)
    s_barrier
    s_endpgm
L_k4_cons:
    s_lshr_b32 s45, s41, 1
    s_lshl_b32 s45, s45, 10
    s_add_u32 s45, s45, 0
    v_add_u32 v4, s45, v3
    s_and_b32 s46, s41, 1
    s_lshl_b32 s46, s46, 10
    s_add_u32 s46, s46, 81920
    v_add_u32 v5, s46, v3
    s_mov_b32 s50, 0
    s_mov_b32 s51, 0
    v_pk_mov_b32 v[16:17], 0, 0
    v_pk_mov_b32 v[18:19], 0, 0
    v_pk_mov_b32 v[20:21], 0, 0
    v_pk_mov_b32 v[22:23], 0, 0
    v_pk_mov_b32 v[24:25], 0, 0
    v_pk_mov_b32 v[26:27], 0, 0
    v_pk_mov_b32 v[28:29], 0, 0
    v_pk_mov_b32 v[30:31], 0, 0
    v_pk_mov_b32 v[64:65], 0, 0
    v_pk_mov_b32 v[66:67], 0, 0
    v_pk_mov_b32 v[68:69], 0, 0
    v_pk_mov_b32 v[70:71], 0, 0
    v_pk_mov_b32 v[72:73], 0, 0
    v_pk_mov_b32 v[74:75], 0, 0
    v_pk_mov_b32 v[76:77], 0, 0
    v_pk_mov_b32 v[78:79], 0, 0
    v_pk_mov_b32 v[80:81], 0, 0
    v_pk_mov_b32 v[82:83], 0, 0
    v_pk_mov_b32 v[84:85], 0, 0
    v_pk_mov_b32 v[86:87], 0, 0
    v_pk_mov_b32 v[88:89], 0, 0
    v_pk_mov_b32 v[90:91], 0, 0
    v_pk_mov_b32 v[92:93], 0, 0
    v_pk_mov_b32 v[94:95], 0, 0
    v_and_b32 v6, 15, v1
    v_lshrrev_b32 v7, 4, v1
    v_lshrrev_b32 v8, 2, v6
    v_and_b32 v9, 3, v6
    v_and_b32 v10, 1, v7
    v_lshrrev_b32 v11, 1, v7
    s_and_b32 s47, s41, 1
    s_lshl_b32 s47, s47, 1
    v_add_u32 v12, s47, v10
    v_xor_b32 v12, v12, v8
    v_lshlrev_b32 v12, 5, v12
    v_lshl_add_u32 v12, v9, 3, v12
    v_lshl_add_u32 v13, v11, 2, v8
    v_lshl_add_u32 v12, v13, 7, v12
    s_lshr_b32 s47, s41, 1
    s_lshl_b32 s47, s47, 12
    s_add_u32 s47, s47, 147456
    v_add_u32 v12, s47, v12
    v_and_b32 v13, 31, v1
    v_lshlrev_b32 v13, 10, v13
    v_lshrrev_b32 v14, 5, v1
    v_lshl_add_u32 v13, v14, 4, v13
    s_lshl_b32 s52, s43, 16
    s_lshl_b32 s53, s44, 7
    s_add_u32 s52, s52, s53
    s_and_b32 s53, s41, 1
    s_lshl_b32 s53, s53, 15
    s_add_u32 s52, s52, s53
    s_lshr_b32 s53, s41, 1
    s_lshl_b32 s53, s53, 6
    s_add_u32 s52, s52, s53
    s_waitcnt lgkmcnt(0)
    s_mov_b32 s28, s36
    s_mov_b32 s29, s37
    s_mov_b32 s30, 0x200000
    s_mov_b32 s31, 0x00020000
L_k4_cl:
    v_add_u32 v14, s50, v4
    v_add_u32 v15, s51, v5
    s_add_u32 s50, s50, 8192
    s_cmp_eq_u32 s50, 81920
    s_cselect_b32 s50, 0, s50
    s_add_u32 s51, s51, 8192
    s_cmp_eq_u32 s51, 65536
    s_cselect_b32 s51, 0, s51
    s_barrier
    s_waitcnt lgkmcnt(6)
    v_mfma_f32_32x32x16_bf16 v[16:31], v[64:67], v[68:71], v[16:31]
    ds_read_b128 v[32:35], v14 offset:0
    ds_read_b128 v[36:39], v15 offset:0
    s_waitcnt lgkmcnt(6)
    v_mfma_f32_32x32x16_bf16 v[16:31], v[72:75], v[76:79], v[16:31]
    ds_read_b128 v[40:43], v14 offset:2048
    ds_read_b128 v[44:47], v15 offset:2048
    s_waitcnt lgkmcnt(6)
    v_mfma_f32_32x32x16_bf16 v[16:31], v[80:83], v[84:87], v[16:31]
    ds_read_b128 v[48:51], v14 offset:4096
    ds_read_b128 v[52:55], v15 offset:4096
    s_waitcnt lgkmcnt(6)
    v_mfma_f32_32x32x16_bf16 v[16:31], v[88:91], v[92:95], v[16:31]
    ds_read_b128 v[56:59], v14 offset:6144
    ds_read_b128 v[60:63], v15 offset:6144
    v_add_u32 v14, s50, v4
    v_add_u32 v15, s51, v5
    s_add_u32 s50, s50, 8192
    s_cmp_eq_u32 s50, 81920
    s_cselect_b32 s50, 0, s50
    s_add_u32 s51, s51, 8192
    s_cmp_eq_u32 s51, 65536
    s_cselect_b32 s51, 0, s51
    s_barrier
    s_waitcnt lgkmcnt(6)
    v_mfma_f32_32x32x16_bf16 v[16:31], v[32:35], v[36:39], v[16:31]
    ds_read_b128 v[64:67], v14 offset:0
    ds_read_b128 v[68:71], v15 offset:0
    s_waitcnt lgkmcnt(6)
    v_mfma_f32_32x32x16_bf16 v[16:31], v[40:43], v[44:47], v[16:31]
    ds_read_b128 v[72:75], v14 offset:2048
    ds_read_b128 v[76:79], v15 offset:2048
    s_waitcnt lgkmcnt(6)
    v_mfma_f32_32x32x16_bf16 v[16:31], v[48:51], v[52:55], v[16:31]
    ds_read_b128 v[80:83], v14 offset:4096
    ds_read_b128 v[84:87], v15 offset:4096
    s_waitcnt lgkmcnt(6)
    v_mfma_f32_32x32x16_bf16 v[16:31], v[56:59], v[60:63], v[16:31]
    ds_read_b128 v[88:91], v14 offset:6144
    ds_read_b128 v[92:95], v15 offset:6144
    s_add_u32 s48, s48, 2
    s_cmp_lt_u32 s48, 28
    s_cbranch_scc1 L_k4_cl
    s_waitcnt lgkmcnt(6)
    v_mfma_f32_32x32x16_bf16 v[16:31], v[64:67], v[68:71], v[16:31]
    s_waitcnt lgkmcnt(4)
    v_mfma_f32_32x32x16_bf16 v[16:31], v[72:75], v[76:79], v[16:31]
    s_waitcnt lgkmcnt(2)
    v_mfma_f32_32x32x16_bf16 v[16:31], v[80:83], v[84:87], v[16:31]
    s_waitcnt lgkmcnt(0)
    v_mfma_f32_32x32x16_bf16 v[16:31], v[88:91], v[92:95], v[16:31]
    ds_read_b64_tr_b16 v[32:33], v12 offset:0
    ds_read_b64_tr_b16 v[34:35], v12 offset:1024
    ds_read_b64_tr_b16 v[36:37], v12 offset:2048
    ds_read_b64_tr_b16 v[38:39], v12 offset:3072
    s_nop 7
    v_cvt_pk_bf16_f32 v40, v16, v17
    v_cvt_pk_bf16_f32 v41, v18, v19
    v_cvt_pk_bf16_f32 v42, v20, v21
    v_cvt_pk_bf16_f32 v43, v22, v23
    v_cvt_pk_bf16_f32 v44, v24, v25
    v_cvt_pk_bf16_f32 v45, v26, v27
    v_cvt_pk_bf16_f32 v46, v28, v29
    v_cvt_pk_bf16_f32 v47, v30, v31
    s_waitcnt lgkmcnt(0)
    v_lshlrev_b32 v16, 16, v40
    v_and_b32 v17, 0xffff0000, v40
    v_lshlrev_b32 v48, 16, v32
    v_and_b32 v49, 0xffff0000, v32
    v_lshlrev_b32 v18, 16, v41
    v_and_b32 v19, 0xffff0000, v41
    v_lshlrev_b32 v50, 16, v33
    v_and_b32 v51, 0xffff0000, v33
    v_lshlrev_b32 v20, 16, v42
    v_and_b32 v21, 0xffff0000, v42
    v_lshlrev_b32 v52, 16, v34
    v_and_b32 v53, 0xffff0000, v34
    v_lshlrev_b32 v22, 16, v43
    v_and_b32 v23, 0xffff0000, v43
    v_lshlrev_b32 v54, 16, v35
    v_and_b32 v55, 0xffff0000, v35
    v_lshlrev_b32 v24, 16, v44
    v_and_b32 v25, 0xffff0000, v44
    v_lshlrev_b32 v56, 16, v36
    v_and_b32 v57, 0xffff0000, v36
    v_lshlrev_b32 v26, 16, v45
    v_and_b32 v27, 0xffff0000, v45
    v_lshlrev_b32 v58, 16, v37
    v_and_b32 v59, 0xffff0000, v37
    v_lshlrev_b32 v28, 16, v46
    v_and_b32 v29, 0xffff0000, v46
    v_lshlrev_b32 v60, 16, v38
    v_and_b32 v61, 0xffff0000, v38
    v_lshlrev_b32 v30, 16, v47
    v_and_b32 v31, 0xffff0000, v47
    v_lshlrev_b32 v62, 16, v39
    v_and_b32 v63, 0xffff0000, v39
    v_add_f32 v16, v16, v48
    v_add_f32 v17, v17, v49
    v_add_f32 v18, v18, v50
    v_add_f32 v19, v19, v51
    v_add_f32 v20, v20, v52
    v_add_f32 v21, v21, v53
    v_add_f32 v22, v22, v54
    v_add_f32 v23, v23, v55
    v_add_f32 v24, v24, v56
    v_add_f32 v25, v25, v57
    v_add_f32 v26, v26, v58
    v_add_f32 v27, v27, v59
    v_add_f32 v28, v28, v60
    v_add_f32 v29, v29, v61
    v_add_f32 v30, v30, v62
    v_add_f32 v31, v31, v63
    v_cvt_pk_bf16_f32 v64, v16, v17
    v_cvt_pk_bf16_f32 v65, v18, v19
    v_cvt_pk_bf16_f32 v66, v20, v21
    v_cvt_pk_bf16_f32 v67, v22, v23
    v_cvt_pk_bf16_f32 v68, v24, v25
    v_cvt_pk_bf16_f32 v69, v26, v27
    v_cvt_pk_bf16_f32 v70, v28, v29
    v_cvt_pk_bf16_f32 v71, v30, v31
    v_permlane32_swap_b32 v64, v66
    v_permlane32_swap_b32 v65, v67
    buffer_store_dwordx4 v[64:67], v13, s[28:31], s52 offen offset:0
    v_permlane32_swap_b32 v68, v70
    v_permlane32_swap_b32 v69, v71
    buffer_store_dwordx4 v[68:71], v13, s[28:31], s52 offen offset:32
L_k4_done:
L_k4_end:
    s_endpgm
L_text_end:
.fill 256, 4, 0xbf800000
s_endpgm
.section .rodata,"a"
.p2align 6
.amdhsa_kernel k1_kernel
  .amdhsa_next_free_vgpr 128
  .amdhsa_next_free_sgpr 102
  .amdhsa_accum_offset 128
  .amdhsa_group_segment_fixed_size 0
  .amdhsa_kernarg_size 112
  .amdhsa_user_sgpr_count 2
  .amdhsa_user_sgpr_kernarg_segment_ptr 1
  .amdhsa_system_sgpr_workgroup_id_x 1
.end_amdhsa_kernel
.p2align 6
.amdhsa_kernel k2_kernel
  .amdhsa_next_free_vgpr 256
  .amdhsa_next_free_sgpr 102
  .amdhsa_accum_offset 256
  .amdhsa_group_segment_fixed_size 0
  .amdhsa_kernarg_size 112
  .amdhsa_user_sgpr_count 2
  .amdhsa_user_sgpr_kernarg_segment_ptr 1
  .amdhsa_system_sgpr_workgroup_id_x 1
.end_amdhsa_kernel
.p2align 6
.amdhsa_kernel k3_kernel
  .amdhsa_next_free_vgpr 256
  .amdhsa_next_free_sgpr 102
  .amdhsa_accum_offset 256
  .amdhsa_group_segment_fixed_size 0
  .amdhsa_kernarg_size 112
  .amdhsa_user_sgpr_count 2
  .amdhsa_user_sgpr_kernarg_segment_ptr 1
  .amdhsa_system_sgpr_workgroup_id_x 1
.end_amdhsa_kernel
.p2align 6
.amdhsa_kernel k4_kernel
  .amdhsa_next_free_vgpr 96
  .amdhsa_next_free_sgpr 102
  .amdhsa_accum_offset 96
  .amdhsa_group_segment_fixed_size 0
  .amdhsa_kernarg_size 112
  .amdhsa_user_sgpr_count 2
  .amdhsa_user_sgpr_kernarg_segment_ptr 1
  .amdhsa_system_sgpr_workgroup_id_x 1
.end_amdhsa_kernel
```
